```python
import torch

def _softmax(x, axis=-1):
    return torch.softmax(x, dim=axis)
def _gelu(x):
    return torch.nn.functional.gelu(x, approximate="tanh")
def _silu(x):
    return torch.nn.functional.silu(x)
def _sigmoid(x):
    return torch.sigmoid(x)
def _layernorm(x, axis=-1, eps=1e-5):
    m = x.mean(dim=axis, keepdim=True)
    v = x.var(dim=axis, keepdim=True, unbiased=False)
    return (x - m) / torch.sqrt(v + eps)
def _scatter_add(tgt, idx, src, axis=0):
    return tgt.clone().index_add_(axis, idx, src)
def _segment_sum(src, seg, n):
    out = torch.zeros((n,) + src.shape[1:], dtype=src.dtype)
    return out.index_add_(0, seg, src)
def _pad(x, pw):
    flat = tuple(v for pair in reversed(pw) for v in pair)
    return torch.nn.functional.pad(x, flat)

kernel_name = 'recurrent_scan__mha_block_cached__swiglu_ffn__decode'

def setup_inputs():

    _w = (lambda a: (lambda t: t.to(torch.bfloat16) if t.is_floating_point() else t)(torch.as_tensor(a)))
    def _A_setup():
        B, Sq, D = 2, 1, 1024
        H, Sk, Dh = 32, 16384, 128
        return {
            "x": _w((lambda *s: torch.randn(*s, dtype=torch.bfloat16) * 0.05)(B, Sq, D)),
            "k_cache": _w((lambda *s: torch.randn(*s, dtype=torch.bfloat16) * 1.6)(B, H, Sk, Dh)),
            "v_cache": _w((lambda *s: torch.randn(*s, dtype=torch.bfloat16) * 0.2)(B, H, Sk, Dh)),
            "wq": _w((lambda *s: torch.randn(*s, dtype=torch.bfloat16) * 1.6)(D, H * Dh) * (D ** -0.5)),
            "wo": _w((lambda *s: torch.randn(*s, dtype=torch.bfloat16) * 0.2)(H * Dh, D) * ((H * Dh) ** -0.5)),
        }
    _A_in = _A_setup()

    def _B_setup():
        B, S, D, F = 2, 1, 1024, 3584
        return {
            "x": _w((lambda *s: torch.randn(*s, dtype=torch.bfloat16) * 0.05)(B, S, D)),
            "w_gate": _w((lambda *s: torch.randn(*s, dtype=torch.bfloat16) * 0.1)(D, F)),
            "w_up": _w((lambda *s: torch.randn(*s, dtype=torch.bfloat16) * 0.1)(D, F)),
            "w_down": _w((lambda *s: torch.randn(*s, dtype=torch.bfloat16) * 0.1)(F, D)),
        }
    _B_in = _B_setup()

    return {
        "A_x": _A_in["x"],
        "A_k_cache": _A_in["k_cache"],
        "A_v_cache": _A_in["v_cache"],
        "A_wq": _A_in["wq"],
        "A_wo": _A_in["wo"],
        "B_x": _B_in["x"],
        "B_w_gate": _B_in["w_gate"],
        "B_w_up": _B_in["w_up"],
        "B_w_down": _B_in["w_down"],
    }

def reference(A_x, A_k_cache, A_v_cache, A_wq, A_wo, B_x, B_w_gate, B_w_up, B_w_down):
    def _A_ref(x, k_cache, v_cache, wq, wo):
        B, Sq, D = x.shape
        H, Dh = 32, 128
        q = (lambda x, *d: x.permute(*d))((x @ wq).reshape(B, Sq, H, Dh), 0, 2, 1, 3)
        scores = torch.einsum("bhqd,bhkd->bhqk", q, k_cache) * (Dh ** -0.5)
        p = _softmax(scores, axis=-1)
        o = torch.einsum("bhqk,bhkd->bhqd", p, v_cache)
        return (lambda x, *d: x.permute(*d))(o, 0, 2, 1, 3).reshape(B, Sq, H * Dh) @ wo

    def _B_ref(x, w_gate, w_up, w_down):
        g = _silu(x @ w_gate)
        u = x @ w_up
        return (g * u) @ w_down

    x = A_x
    xn = _layernorm(x, axis=-1)
    s = _A_ref(xn, A_k_cache, A_v_cache, A_wq, A_wo)
    g = _silu(_B_ref(xn, B_w_gate, B_w_up, B_w_down))
    return x + s * g
```

```asm
; @launch grid=(256,1,1) block=(512,1,1) lds=40448
.amdgcn_target "amdgcn-amd-amdhsa--gfx950"
.text
.globl recurrent_scan__mha_block_cached__swiglu_ffn__decode_kernel
.p2align 8
.type recurrent_scan__mha_block_cached__swiglu_ffn__decode_kernel,@function
recurrent_scan__mha_block_cached__swiglu_ffn__decode_kernel:
s_cmp_ge_u32 s2, 256
s_cbranch_scc1 L_end
s_load_dwordx16 s[8:23], s[0:1], 0
s_load_dwordx8 s[24:31], s[0:1], 64
v_and_b32 v1, 63, v0
v_lshrrev_b32 v3, 6, v0
v_lshlrev_b32 v2, 4, v1
v_readfirstlane_b32 s3, v3
s_and_b32 s37, s2, 7
s_lshl_b32 s32, s37, 2
s_lshr_b32 s38, s2, 3
s_and_b32 s37, s38, 3
s_add_u32 s32, s32, s37
s_lshr_b32 s33, s38, 2
s_lshr_b32 s34, s33, 2
s_and_b32 s35, s33, 3
s_lshl_b32 s45, s32, 3
s_add_u32 s45, s45, s33
s_lshl_b32 s82, s33, 5
s_add_u32 s82, s82, s32
s_lshl_b32 s82, s82, 10
s_mul_i32 s44, s2, 49152
s_and_b32 s44, s44, 0xfffff
s_sub_u32 s36, s3, 4
v_lshrrev_b32 v60, 4, v1
v_and_b32 v61, 15, v1
v_lshlrev_b32 v80, 13, v60
v_lshl_add_u32 v80, v61, 4, v80
s_waitcnt lgkmcnt(0)
s_add_u32 s78, s30, 5242880
s_addc_u32 s79, s31, 0
s_load_dword s83, s[78:79], 0
s_mov_b32 s56, s8
s_mov_b32 s57, s9
s_mov_b32 s58, 4096
s_mov_b32 s59, 0x20000
s_cmp_ge_u32 s3, 4
s_cbranch_scc1 L_helper_issue
s_and_b32 s37, s3, 1
s_lshl_b32 s37, s37, 11
s_load_dword s52, s[8:9], s37
s_lshr_b32 s38, s3, 1
s_lshl_b32 s38, s38, 10
s_add_u32 s37, s37, s38
buffer_load_dwordx4 v[68:71], v2, s[56:59], s37 offen
s_lshl_b32 s37, s32, 8
s_add_u32 s84, s14, s37
s_addc_u32 s85, s15, 0
s_mov_b32 s86, 8380672
s_mov_b32 s87, 0x20000
s_lshl_b32 s37, s33, 5
s_lshl_b32 s38, s3, 3
s_add_u32 s37, s37, s38
s_lshl_b32 s42, s37, 15
buffer_load_dwordx4 v[192:195], v80, s[84:87], s42 offen nt
s_add_u32 s42, s42, 32768
buffer_load_dwordx4 v[196:199], v80, s[84:87], s42 offen nt
s_add_u32 s42, s42, 32768
buffer_load_dwordx4 v[200:203], v80, s[84:87], s42 offen nt
s_add_u32 s42, s42, 32768
buffer_load_dwordx4 v[204:207], v80, s[84:87], s42 offen nt
s_add_u32 s42, s42, 32768
buffer_load_dwordx4 v[208:211], v80, s[84:87], s42 offen nt
s_add_u32 s42, s42, 32768
buffer_load_dwordx4 v[212:215], v80, s[84:87], s42 offen nt
s_add_u32 s42, s42, 32768
buffer_load_dwordx4 v[216:219], v80, s[84:87], s42 offen nt
s_add_u32 s42, s42, 32768
buffer_load_dwordx4 v[220:223], v80, s[84:87], s42 offen nt
v_mov_b32 v44, 0
v_lshlrev_b32 v45, 2, v1
s_mov_b64 exec, 0xffff
ds_write_b32 v45, v44 offset:11008
s_mov_b64 exec, -1
s_mov_b32 s72, s30
s_mov_b32 s73, s31
s_mov_b32 s74, 16777216
s_mov_b32 s75, 0x20000
s_mov_b32 s60, s8
s_mov_b32 s61, s9
s_mov_b32 s62, 0
s_mov_b32 s63, 0x20000
s_lshl_b32 s37, s34, 5
s_add_u32 s37, s37, s32
s_lshl_b32 s37, s37, 2
s_add_u32 s37, s37, s35
s_lshl_b32 s37, s37, 20
s_add_u32 s64, s10, s37
s_addc_u32 s65, s11, 0
s_mov_b32 s66, 1048576
s_mov_b32 s67, 0x20000
s_add_u32 s68, s12, s37
s_addc_u32 s69, s13, 0
s_mov_b32 s70, 1048576
s_mov_b32 s71, 0x20000
s_lshl_b32 s37, s3, 12
s_add_u32 s41, s44, s37
v_mov_b32 v81, 0
v_mov_b32 v82, 0
v_mov_b32 v83, 0
v_mov_b32 v88, 0
v_mov_b32 v90, 0
s_waitcnt lgkmcnt(0)
s_barrier
v_and_b32 v62, 1, v61
v_lshlrev_b32 v62, 4, v62
v_mov_b32 v63, 0xffff
v_lshlrev_b32 v63, v62, v63
v_bfe_u32 v64, v61, 1, 2
v_cmp_eq_u32 vcc, 0, v64
s_nop 1
v_cndmask_b32 v4, 0, v63, vcc
v_cmp_eq_u32 vcc, 1, v64
s_nop 1
v_cndmask_b32 v5, 0, v63, vcc
v_cmp_eq_u32 vcc, 2, v64
s_nop 1
v_cndmask_b32 v6, 0, v63, vcc
v_cmp_eq_u32 vcc, 3, v64
s_nop 1
v_cndmask_b32 v7, 0, v63, vcc
v_lshrrev_b32 v62, 3, v61
v_lshl_add_u32 v66, v62, 2, v60
v_mul_u32_u24 v65, 1040, v66
s_mov_b32 s46, 0xaaaaaaaa
s_mov_b32 s47, 0xaaaaaaaa
s_mov_b32 s48, 0xcccccccc
s_mov_b32 s49, 0xcccccccc
s_add_u32 s83, s83, 1
s_lshl_b32 s52, s52, 16
s_waitcnt vmcnt(8)
s_and_b32 s42, s41, 0xfffff
buffer_load_dwordx4 v[128:131], v2, s[64:67], s42 offen offset:0 nt
buffer_load_dwordx4 v[132:135], v2, s[64:67], s42 offen offset:1024 nt
v_lshlrev_b32 v28, 16, v68
v_and_b32 v29, 0xffff0000, v68
v_lshlrev_b32 v30, 16, v69
v_and_b32 v31, 0xffff0000, v69
v_lshlrev_b32 v32, 16, v70
v_and_b32 v33, 0xffff0000, v70
v_lshlrev_b32 v34, 16, v71
v_and_b32 v35, 0xffff0000, v71
v_subrev_f32 v36, s52, v28
v_subrev_f32 v37, s52, v29
v_subrev_f32 v38, s52, v30
v_subrev_f32 v39, s52, v31
v_subrev_f32 v40, s52, v32
v_subrev_f32 v41, s52, v33
v_subrev_f32 v42, s52, v34
v_subrev_f32 v43, s52, v35
v_add_f32 v44, v36, v37
v_mul_f32 v45, v36, v36
v_add_f32 v46, v38, v39
v_mul_f32 v47, v37, v37
v_add_f32 v44, v44, v40
v_add_f32 v46, v46, v41
v_add_f32 v44, v44, v42
v_add_f32 v46, v46, v43
v_fmac_f32 v45, v38, v38
v_fmac_f32 v47, v39, v39
v_fmac_f32 v45, v40, v40
v_fmac_f32 v47, v41, v41
v_fmac_f32 v45, v42, v42
v_fmac_f32 v47, v43, v43
v_add_f32 v44, v44, v46
v_add_f32 v45, v45, v47
s_nop 0
v_add_f32_dpp v44, v44, v44 row_ror:8 row_mask:0xf bank_mask:0xf
v_add_f32_dpp v45, v45, v45 row_ror:8 row_mask:0xf bank_mask:0xf
s_and_b32 s37, s3, 1
s_mul_i32 s38, s37, 4160
v_add_f32_dpp v44, v44, v44 row_ror:4 row_mask:0xf bank_mask:0xf
v_add_f32_dpp v45, v45, v45 row_ror:4 row_mask:0xf bank_mask:0xf
s_lshr_b32 s39, s3, 1
s_lshl_b32 s40, s39, 9
v_add_f32_dpp v44, v44, v44 row_ror:2 row_mask:0xf bank_mask:0xf
v_add_f32_dpp v45, v45, v45 row_ror:2 row_mask:0xf bank_mask:0xf
s_add_u32 s38, s38, s40
s_lshl_b32 s37, s37, 4
v_add_f32_dpp v44, v44, v44 row_ror:1 row_mask:0xf bank_mask:0xf
v_add_f32_dpp v45, v45, v45 row_ror:1 row_mask:0xf bank_mask:0xf
s_lshl_b32 s39, s39, 3
s_add_u32 s39, s39, s37
v_mov_b32 v46, v44
v_mov_b32 v47, v45
s_nop 0
v_permlane16_swap_b32 v44, v46
v_permlane16_swap_b32 v45, v47
v_add_f32 v44, v44, v46
v_add_f32 v45, v45, v47
v_mov_b32 v46, v44
v_mov_b32 v47, v45
s_nop 0
v_permlane32_swap_b32 v44, v46
v_permlane32_swap_b32 v45, v47
v_add_f32 v44, v44, v46
v_add_f32 v45, v45, v47
v_lshlrev_b32 v72, 3, v1
v_add_u32 v72, s38, v72
v_mov_b32 v46, s39
v_mov_b32 v73, s37
s_mov_b64 exec, 1
ds_write_b64 v46, v[44:45] offset:19776
s_mov_b64 exec, -1
s_waitcnt lgkmcnt(0)
v_mov_b32 v3, 11036
v_mov_b32 v127, 1
s_mov_b64 exec, 1
ds_add_u32 v3, v127
s_mov_b64 exec, -1
v_mov_b32 v3, 11036
s_mov_b32 s51, 1600000
Lw_1:
ds_read_b32 v127, v3
s_waitcnt lgkmcnt(0)
v_readfirstlane_b32 s37, v127
s_nop 0
s_cmp_ge_u32 s37, 4
s_cbranch_scc1 Lw_1_ok
s_sub_u32 s51, s51, 1
s_cmp_lg_u32 s51, 0
s_cbranch_scc1 Lw_1
Lw_1_ok:
ds_read_b128 v[36:39], v73 offset:19776
s_waitcnt lgkmcnt(0)
v_add_f32 v44, v36, v38
v_add_f32 v45, v37, v39
v_mul_f32 v44, 0x3a800000, v44
v_mul_f32 v45, 0x3a800000, v45
v_add_f32 v50, s52, v44
v_fma_f32 v44, -v44, v44, v45
v_max_f32 v44, 0, v44
v_cvt_pk_bf16_f32 v44, v44, v44
v_and_b32 v44, 0xffff0000, v44
v_add_f32 v44, 0x3727c5ac, v44
v_cvt_pk_bf16_f32 v44, v44, v44
v_and_b32 v44, 0xffff0000, v44
v_sqrt_f32 v47, v44
v_cvt_pk_bf16_f32 v50, v50, v50
v_and_b32 v50, 0xffff0000, v50
v_rcp_f32 v48, v47
v_fma_f32 v49, -v47, v47, v44
v_mul_f32 v49, 0.5, v49
v_fma_f32 v47, v49, v48, v47
v_cvt_pk_bf16_f32 v47, v47, v47
v_and_b32 v47, 0xffff0000, v47
v_rcp_f32 v48, v47
v_sub_f32 v28, v28, v50
v_sub_f32 v29, v29, v50
v_sub_f32 v30, v30, v50
v_sub_f32 v31, v31, v50
v_sub_f32 v32, v32, v50
v_sub_f32 v33, v33, v50
v_sub_f32 v34, v34, v50
v_sub_f32 v35, v35, v50
v_cvt_pk_bf16_f32 v28, v28, v28
v_and_b32 v28, 0xffff0000, v28
v_cvt_pk_bf16_f32 v29, v29, v29
v_and_b32 v29, 0xffff0000, v29
v_cvt_pk_bf16_f32 v30, v30, v30
v_and_b32 v30, 0xffff0000, v30
v_cvt_pk_bf16_f32 v31, v31, v31
v_and_b32 v31, 0xffff0000, v31
v_cvt_pk_bf16_f32 v32, v32, v32
v_and_b32 v32, 0xffff0000, v32
v_cvt_pk_bf16_f32 v33, v33, v33
v_and_b32 v33, 0xffff0000, v33
v_cvt_pk_bf16_f32 v34, v34, v34
v_and_b32 v34, 0xffff0000, v34
v_cvt_pk_bf16_f32 v35, v35, v35
v_and_b32 v35, 0xffff0000, v35
v_mul_f32 v36, v28, v48
v_mul_f32 v37, v29, v48
v_mul_f32 v38, v30, v48
v_mul_f32 v39, v31, v48
v_mul_f32 v40, v32, v48
v_mul_f32 v41, v33, v48
v_mul_f32 v42, v34, v48
v_mul_f32 v43, v35, v48
v_fma_f32 v52, -v36, v47, v28
v_fma_f32 v53, -v37, v47, v29
v_fma_f32 v54, -v38, v47, v30
v_fma_f32 v55, -v39, v47, v31
v_fma_f32 v56, -v40, v47, v32
v_fma_f32 v57, -v41, v47, v33
v_fma_f32 v58, -v42, v47, v34
v_fma_f32 v59, -v43, v47, v35
v_fma_f32 v36, v52, v48, v36
v_fma_f32 v37, v53, v48, v37
v_fma_f32 v38, v54, v48, v38
v_fma_f32 v39, v55, v48, v39
v_fma_f32 v40, v56, v48, v40
v_fma_f32 v41, v57, v48, v41
v_fma_f32 v42, v58, v48, v42
v_fma_f32 v43, v59, v48, v43
v_cvt_pk_bf16_f32 v28, v36, v36
v_cvt_pk_bf16_f32 v29, v40, v40
v_cvt_pk_bf16_f32 v30, v37, v37
v_cvt_pk_bf16_f32 v31, v41, v41
v_cvt_pk_bf16_f32 v32, v38, v38
v_cvt_pk_bf16_f32 v33, v42, v42
v_cvt_pk_bf16_f32 v34, v39, v39
v_cvt_pk_bf16_f32 v35, v43, v43
ds_write_b64 v72, v[28:29] offset:0
ds_write_b64 v72, v[30:31] offset:1040
ds_write_b64 v72, v[32:33] offset:2080
ds_write_b64 v72, v[34:35] offset:3120
s_waitcnt lgkmcnt(0)
v_mov_b32 v3, 11040
v_mov_b32 v127, 1
s_mov_b64 exec, 1
ds_add_u32 v3, v127
s_mov_b64 exec, -1
s_lshl_b32 s37, s33, 7
s_lshl_b32 s38, s3, 5
s_add_u32 s37, s37, s38
v_add_u32 v84, s37, v65
v_mov_b32 v16, 0
v_mov_b32 v17, 0
v_mov_b32 v18, 0
v_mov_b32 v19, 0
v_mov_b32 v3, 11040
s_mov_b32 s51, 1600000
Lw_2:
ds_read_b32 v127, v3
s_waitcnt lgkmcnt(0)
v_readfirstlane_b32 s37, v127
s_nop 0
s_cmp_ge_u32 s37, 4
s_cbranch_scc1 Lw_2_ok
s_sub_u32 s51, s51, 1
s_cmp_lg_u32 s51, 0
s_cbranch_scc1 Lw_2
Lw_2_ok:
ds_read_b128 v[44:47], v84 offset:0
ds_read_b128 v[48:51], v84 offset:16
s_lshl_b32 s37, s3, 10
v_add_u32 v85, s37, v2
s_waitcnt vmcnt(2)
s_waitcnt lgkmcnt(0)
v_and_b32 v8, v44, v4
v_and_b32 v9, v44, v5
v_and_b32 v10, v44, v6
v_and_b32 v11, v44, v7
v_and_b32 v12, v45, v4
v_and_b32 v13, v45, v5
v_and_b32 v14, v45, v6
v_and_b32 v15, v45, v7
v_mfma_f32_16x16x32_bf16 v[16:19], v[8:11], v[192:195], v[16:19]
v_and_b32 v8, v46, v4
v_and_b32 v9, v46, v5
v_and_b32 v10, v46, v6
v_and_b32 v11, v46, v7
v_mfma_f32_16x16x32_bf16 v[16:19], v[12:15], v[196:199], v[16:19]
v_and_b32 v12, v47, v4
v_and_b32 v13, v47, v5
v_and_b32 v14, v47, v6
v_and_b32 v15, v47, v7
v_mfma_f32_16x16x32_bf16 v[16:19], v[8:11], v[200:203], v[16:19]
v_and_b32 v8, v48, v4
v_and_b32 v9, v48, v5
v_and_b32 v10, v48, v6
v_and_b32 v11, v48, v7
v_mfma_f32_16x16x32_bf16 v[16:19], v[12:15], v[204:207], v[16:19]
v_and_b32 v12, v49, v4
v_and_b32 v13, v49, v5
v_and_b32 v14, v49, v6
v_and_b32 v15, v49, v7
v_mfma_f32_16x16x32_bf16 v[16:19], v[8:11], v[208:211], v[16:19]
v_and_b32 v8, v50, v4
v_and_b32 v9, v50, v5
v_and_b32 v10, v50, v6
v_and_b32 v11, v50, v7
v_mfma_f32_16x16x32_bf16 v[16:19], v[12:15], v[212:215], v[16:19]
v_and_b32 v12, v51, v4
v_and_b32 v13, v51, v5
v_and_b32 v14, v51, v6
v_and_b32 v15, v51, v7
v_mfma_f32_16x16x32_bf16 v[16:19], v[8:11], v[216:219], v[16:19]
s_nop 0
v_mfma_f32_16x16x32_bf16 v[16:19], v[12:15], v[220:223], v[16:19]
s_nop 7
ds_write_b128 v85, v[16:19] offset:11264
s_waitcnt lgkmcnt(0)
v_mov_b32 v3, 11044
v_mov_b32 v127, 1
s_mov_b64 exec, 1
ds_add_u32 v3, v127
s_mov_b64 exec, -1
s_waitcnt vmcnt(1)
s_and_b32 s42, s41, 0xfffff
buffer_load_dwordx4 v[136:139], v2, s[64:67], s42 offen offset:2048 nt
s_waitcnt vmcnt(1)
buffer_load_dwordx4 v[140:143], v2, s[64:67], s42 offen offset:3072 nt
s_waitcnt vmcnt(1)
s_add_u32 s42, s41, 16384
s_and_b32 s42, s42, 0xfffff
buffer_load_dwordx4 v[144:147], v2, s[64:67], s42 offen offset:0 nt
s_waitcnt vmcnt(1)
buffer_load_dwordx4 v[148:151], v2, s[64:67], s42 offen offset:1024 nt
s_waitcnt vmcnt(1)
buffer_load_dwordx4 v[152:155], v2, s[64:67], s42 offen offset:2048 nt
s_waitcnt vmcnt(1)
buffer_load_dwordx4 v[156:159], v2, s[64:67], s42 offen offset:3072 nt
s_waitcnt vmcnt(1)
s_add_u32 s42, s41, 32768
s_and_b32 s42, s42, 0xfffff
buffer_load_dwordx4 v[160:163], v2, s[64:67], s42 offen offset:0 nt
s_waitcnt vmcnt(1)
buffer_load_dwordx4 v[164:167], v2, s[64:67], s42 offen offset:1024 nt
s_waitcnt vmcnt(1)
buffer_load_dwordx4 v[168:171], v2, s[64:67], s42 offen offset:2048 nt
s_waitcnt vmcnt(1)
buffer_load_dwordx4 v[172:175], v2, s[64:67], s42 offen offset:3072 nt
v_mov_b32 v3, 11008
s_mov_b32 s51, 1600000
Lw_3:
ds_read_b32 v127, v3
s_waitcnt lgkmcnt(0)
v_readfirstlane_b32 s37, v127
s_nop 0
s_cmp_ge_u32 s37, 1
s_cbranch_scc1 Lw_3_ok
s_sub_u32 s51, s51, 1
s_cmp_lg_u32 s51, 0
s_cbranch_scc1 Lw_3
Lw_3_ok:
v_lshlrev_b32 v3, 4, v61
ds_read_b128 v[24:27], v3 offset:19456
v_mov_b32 v85, 0xff800000
v_mov_b32 v89, 0
s_lshl_b32 s37, s3, 12
v_lshlrev_b32 v86, 2, v1
v_add_u32 v86, s37, v86
s_waitcnt lgkmcnt(0)
s_waitcnt vmcnt(11)
v_dot2_f32_bf16 v28, v128, v24, 0
v_dot2_f32_bf16 v28, v129, v25, v28
v_dot2_f32_bf16 v28, v130, v26, v28
v_dot2_f32_bf16 v28, v131, v27, v28
s_waitcnt vmcnt(10)
s_add_u32 s42, s41, 49152
s_and_b32 s42, s42, 0xfffff
buffer_load_dwordx4 v[176:179], v2, s[64:67], s42 offen offset:0 nt
v_dot2_f32_bf16 v29, v132, v24, 0
v_dot2_f32_bf16 v29, v133, v25, v29
v_dot2_f32_bf16 v29, v134, v26, v29
v_dot2_f32_bf16 v29, v135, v27, v29
s_waitcnt vmcnt(10)
buffer_load_dwordx4 v[180:183], v2, s[64:67], s42 offen offset:1024 nt
v_dot2_f32_bf16 v30, v136, v24, 0
v_dot2_f32_bf16 v30, v137, v25, v30
v_dot2_f32_bf16 v30, v138, v26, v30
v_dot2_f32_bf16 v30, v139, v27, v30
s_waitcnt vmcnt(10)
buffer_load_dwordx4 v[184:187], v2, s[64:67], s42 offen offset:2048 nt
v_dot2_f32_bf16 v31, v140, v24, 0
v_dot2_f32_bf16 v31, v141, v25, v31
v_dot2_f32_bf16 v31, v142, v26, v31
v_dot2_f32_bf16 v31, v143, v27, v31
s_waitcnt vmcnt(10)
buffer_load_dwordx4 v[188:191], v2, s[64:67], s42 offen offset:3072 nt
v_dot2_f32_bf16 v32, v144, v24, 0
v_dot2_f32_bf16 v32, v145, v25, v32
v_dot2_f32_bf16 v32, v146, v26, v32
v_dot2_f32_bf16 v32, v147, v27, v32
s_waitcnt vmcnt(10)
s_add_u32 s42, s41, 65536
s_and_b32 s42, s42, 0xfffff
buffer_load_dwordx4 v[192:195], v2, s[64:67], s42 offen offset:0 nt
v_dot2_f32_bf16 v33, v148, v24, 0
v_dot2_f32_bf16 v33, v149, v25, v33
v_dot2_f32_bf16 v33, v150, v26, v33
v_dot2_f32_bf16 v33, v151, v27, v33
s_waitcnt vmcnt(10)
buffer_load_dwordx4 v[196:199], v2, s[64:67], s42 offen offset:1024 nt
v_dot2_f32_bf16 v34, v152, v24, 0
v_dot2_f32_bf16 v34, v153, v25, v34
v_dot2_f32_bf16 v34, v154, v26, v34
v_dot2_f32_bf16 v34, v155, v27, v34
s_waitcnt vmcnt(10)
v_dot2_f32_bf16 v35, v156, v24, 0
v_dot2_f32_bf16 v35, v157, v25, v35
v_dot2_f32_bf16 v35, v158, v26, v35
v_dot2_f32_bf16 v35, v159, v27, v35
s_waitcnt vmcnt(9)
v_dot2_f32_bf16 v36, v160, v24, 0
v_dot2_f32_bf16 v36, v161, v25, v36
v_dot2_f32_bf16 v36, v162, v26, v36
v_dot2_f32_bf16 v36, v163, v27, v36
s_waitcnt vmcnt(8)
v_dot2_f32_bf16 v37, v164, v24, 0
v_dot2_f32_bf16 v37, v165, v25, v37
v_dot2_f32_bf16 v37, v166, v26, v37
v_dot2_f32_bf16 v37, v167, v27, v37
s_waitcnt vmcnt(7)
v_dot2_f32_bf16 v38, v168, v24, 0
v_dot2_f32_bf16 v38, v169, v25, v38
v_dot2_f32_bf16 v38, v170, v26, v38
v_dot2_f32_bf16 v38, v171, v27, v38
s_waitcnt vmcnt(6)
v_dot2_f32_bf16 v39, v172, v24, 0
v_dot2_f32_bf16 v39, v173, v25, v39
v_dot2_f32_bf16 v39, v174, v26, v39
v_dot2_f32_bf16 v39, v175, v27, v39
s_waitcnt vmcnt(5)
buffer_load_dwordx4 v[200:203], v2, s[64:67], s42 offen offset:2048 nt
v_dot2_f32_bf16 v40, v176, v24, 0
v_dot2_f32_bf16 v40, v177, v25, v40
v_dot2_f32_bf16 v40, v178, v26, v40
v_dot2_f32_bf16 v40, v179, v27, v40
s_waitcnt vmcnt(5)
buffer_load_dwordx4 v[204:207], v2, s[64:67], s42 offen offset:3072 nt
v_dot2_f32_bf16 v41, v180, v24, 0
v_dot2_f32_bf16 v41, v181, v25, v41
v_dot2_f32_bf16 v41, v182, v26, v41
v_dot2_f32_bf16 v41, v183, v27, v41
s_waitcnt vmcnt(5)
s_add_u32 s42, s41, 81920
s_and_b32 s42, s42, 0xfffff
buffer_load_dwordx4 v[208:211], v2, s[64:67], s42 offen offset:0 nt
v_dot2_f32_bf16 v42, v184, v24, 0
v_dot2_f32_bf16 v42, v185, v25, v42
v_dot2_f32_bf16 v42, v186, v26, v42
v_dot2_f32_bf16 v42, v187, v27, v42
s_waitcnt vmcnt(5)
buffer_load_dwordx4 v[212:215], v2, s[64:67], s42 offen offset:1024 nt
v_dot2_f32_bf16 v43, v188, v24, 0
v_dot2_f32_bf16 v43, v189, v25, v43
v_dot2_f32_bf16 v43, v190, v26, v43
v_dot2_f32_bf16 v43, v191, v27, v43
s_waitcnt vmcnt(5)
buffer_load_dwordx4 v[216:219], v2, s[64:67], s42 offen offset:2048 nt
v_dot2_f32_bf16 v44, v192, v24, 0
v_dot2_f32_bf16 v44, v193, v25, v44
v_dot2_f32_bf16 v44, v194, v26, v44
v_dot2_f32_bf16 v44, v195, v27, v44
v_add_f32_dpp v28, v28, v28 row_ror:8 row_mask:0xf bank_mask:0x3
v_add_f32_dpp v29, v29, v29 row_ror:8 row_mask:0xf bank_mask:0x3
v_add_f32_dpp v30, v30, v30 row_ror:8 row_mask:0xf bank_mask:0x3
v_add_f32_dpp v31, v31, v31 row_ror:8 row_mask:0xf bank_mask:0x3
s_waitcnt vmcnt(5)
buffer_load_dwordx4 v[220:223], v2, s[64:67], s42 offen offset:3072 nt
v_dot2_f32_bf16 v45, v196, v24, 0
v_dot2_f32_bf16 v45, v197, v25, v45
v_dot2_f32_bf16 v45, v198, v26, v45
v_dot2_f32_bf16 v45, v199, v27, v45
v_add_f32_dpp v32, v32, v32 row_ror:8 row_mask:0xf bank_mask:0x3
v_add_f32_dpp v33, v33, v33 row_ror:8 row_mask:0xf bank_mask:0x3
v_add_f32_dpp v34, v34, v34 row_ror:8 row_mask:0xf bank_mask:0x3
v_add_f32_dpp v35, v35, v35 row_ror:8 row_mask:0xf bank_mask:0x3
s_waitcnt vmcnt(5)
s_add_u32 s42, s41, 98304
s_and_b32 s42, s42, 0xfffff
buffer_load_dwordx4 v[224:227], v2, s[64:67], s42 offen offset:0 nt
v_dot2_f32_bf16 v46, v200, v24, 0
v_dot2_f32_bf16 v46, v201, v25, v46
v_dot2_f32_bf16 v46, v202, v26, v46
v_dot2_f32_bf16 v46, v203, v27, v46
v_add_f32_dpp v28, v36, v36 row_ror:8 row_mask:0xf bank_mask:0xc
v_add_f32_dpp v29, v37, v37 row_ror:8 row_mask:0xf bank_mask:0xc
v_add_f32_dpp v30, v38, v38 row_ror:8 row_mask:0xf bank_mask:0xc
v_add_f32_dpp v31, v39, v39 row_ror:8 row_mask:0xf bank_mask:0xc
s_waitcnt vmcnt(5)
buffer_load_dwordx4 v[228:231], v2, s[64:67], s42 offen offset:1024 nt
v_dot2_f32_bf16 v47, v204, v24, 0
v_dot2_f32_bf16 v47, v205, v25, v47
v_dot2_f32_bf16 v47, v206, v26, v47
v_dot2_f32_bf16 v47, v207, v27, v47
v_add_f32_dpp v32, v40, v40 row_ror:8 row_mask:0xf bank_mask:0xc
v_add_f32_dpp v33, v41, v41 row_ror:8 row_mask:0xf bank_mask:0xc
v_add_f32_dpp v34, v42, v42 row_ror:8 row_mask:0xf bank_mask:0xc
v_add_f32_dpp v35, v43, v43 row_ror:8 row_mask:0xf bank_mask:0xc
s_waitcnt vmcnt(5)
buffer_load_dwordx4 v[232:235], v2, s[64:67], s42 offen offset:2048 nt
v_dot2_f32_bf16 v48, v208, v24, 0
v_dot2_f32_bf16 v48, v209, v25, v48
v_dot2_f32_bf16 v48, v210, v26, v48
v_dot2_f32_bf16 v48, v211, v27, v48
v_add_f32_dpp v28, v28, v28 row_shl:4 row_mask:0xf bank_mask:0x5
v_add_f32_dpp v29, v29, v29 row_shl:4 row_mask:0xf bank_mask:0x5
v_add_f32_dpp v30, v30, v30 row_shl:4 row_mask:0xf bank_mask:0x5
v_add_f32_dpp v31, v31, v31 row_shl:4 row_mask:0xf bank_mask:0x5
s_waitcnt vmcnt(5)
buffer_load_dwordx4 v[236:239], v2, s[64:67], s42 offen offset:3072 nt
v_dot2_f32_bf16 v49, v212, v24, 0
v_dot2_f32_bf16 v49, v213, v25, v49
v_dot2_f32_bf16 v49, v214, v26, v49
v_dot2_f32_bf16 v49, v215, v27, v49
v_add_f32_dpp v28, v32, v32 row_shr:4 row_mask:0xf bank_mask:0xa
v_add_f32_dpp v29, v33, v33 row_shr:4 row_mask:0xf bank_mask:0xa
v_add_f32_dpp v30, v34, v34 row_shr:4 row_mask:0xf bank_mask:0xa
v_add_f32_dpp v31, v35, v35 row_shr:4 row_mask:0xf bank_mask:0xa
s_waitcnt vmcnt(5)
s_add_u32 s42, s41, 114688
s_and_b32 s42, s42, 0xfffff
buffer_load_dwordx4 v[240:243], v2, s[64:67], s42 offen offset:0 nt
v_dot2_f32_bf16 v50, v216, v24, 0
v_dot2_f32_bf16 v50, v217, v25, v50
v_dot2_f32_bf16 v50, v218, v26, v50
v_dot2_f32_bf16 v50, v219, v27, v50
v_add_f32_dpp v36, v28, v28 quad_perm:[2,3,0,1] row_mask:0xf bank_mask:0xf
v_add_f32_dpp v37, v29, v29 quad_perm:[2,3,0,1] row_mask:0xf bank_mask:0xf
v_add_f32_dpp v38, v30, v30 quad_perm:[2,3,0,1] row_mask:0xf bank_mask:0xf
v_add_f32_dpp v39, v31, v31 quad_perm:[2,3,0,1] row_mask:0xf bank_mask:0xf
s_waitcnt vmcnt(5)
buffer_load_dwordx4 v[244:247], v2, s[64:67], s42 offen offset:1024 nt
v_dot2_f32_bf16 v51, v220, v24, 0
v_dot2_f32_bf16 v51, v221, v25, v51
v_dot2_f32_bf16 v51, v222, v26, v51
v_dot2_f32_bf16 v51, v223, v27, v51
v_cndmask_b32 v28, v36, v38, s[48:49]
v_cndmask_b32 v29, v37, v39, s[48:49]
s_nop 0
v_add_f32_dpp v36, v28, v28 quad_perm:[1,0,3,2] row_mask:0xf bank_mask:0xf
v_add_f32_dpp v37, v29, v29 quad_perm:[1,0,3,2] row_mask:0xf bank_mask:0xf
s_waitcnt vmcnt(5)
buffer_load_dwordx4 v[248:251], v2, s[64:67], s42 offen offset:2048 nt
v_dot2_f32_bf16 v52, v224, v24, 0
v_dot2_f32_bf16 v52, v225, v25, v52
v_dot2_f32_bf16 v52, v226, v26, v52
v_dot2_f32_bf16 v52, v227, v27, v52
v_cndmask_b32 v87, v36, v37, s[46:47]
v_cvt_pk_bf16_f32 v87, v87, v87
v_and_b32 v87, 0xffff0000, v87
v_mul_f32 v87, 0x3db504f3, v87
s_waitcnt vmcnt(5)
buffer_load_dwordx4 v[252:255], v2, s[64:67], s42 offen offset:3072 nt
v_dot2_f32_bf16 v53, v228, v24, 0
v_dot2_f32_bf16 v53, v229, v25, v53
v_dot2_f32_bf16 v53, v230, v26, v53
v_dot2_f32_bf16 v53, v231, v27, v53
v_cvt_pk_bf16_f32 v87, v87, v87
v_and_b32 v87, 0xffff0000, v87
ds_write_b32 v86, v87 offset:24064
v_max_f32 v88, v85, v87
s_waitcnt vmcnt(5)
s_add_u32 s42, s41, 131072
s_and_b32 s42, s42, 0xfffff
buffer_load_dwordx4 v[128:131], v2, s[64:67], s42 offen offset:0 nt
v_dot2_f32_bf16 v54, v232, v24, 0
v_dot2_f32_bf16 v54, v233, v25, v54
v_dot2_f32_bf16 v54, v234, v26, v54
v_dot2_f32_bf16 v54, v235, v27, v54
v_sub_f32 v90, v85, v88
v_sub_f32 v91, v87, v88
v_mul_f32 v90, 0x3fb8aa3b, v90
v_mul_f32 v91, 0x3fb8aa3b, v91
s_waitcnt vmcnt(5)
buffer_load_dwordx4 v[132:135], v2, s[64:67], s42 offen offset:1024 nt
v_dot2_f32_bf16 v55, v236, v24, 0
v_dot2_f32_bf16 v55, v237, v25, v55
v_dot2_f32_bf16 v55, v238, v26, v55
v_dot2_f32_bf16 v55, v239, v27, v55
v_exp_f32 v90, v90
v_exp_f32 v91, v91
v_mov_b32 v85, v88
v_add_u32 v86, 256, v86
s_waitcnt vmcnt(5)
buffer_load_dwordx4 v[136:139], v2, s[64:67], s42 offen offset:2048 nt
v_dot2_f32_bf16 v56, v240, v24, 0
v_dot2_f32_bf16 v56, v241, v25, v56
v_dot2_f32_bf16 v56, v242, v26, v56
v_dot2_f32_bf16 v56, v243, v27, v56
v_fma_f32 v89, v89, v90, v91
s_waitcnt vmcnt(5)
buffer_load_dwordx4 v[140:143], v2, s[64:67], s42 offen offset:3072 nt
v_dot2_f32_bf16 v57, v244, v24, 0
v_dot2_f32_bf16 v57, v245, v25, v57
v_dot2_f32_bf16 v57, v246, v26, v57
v_dot2_f32_bf16 v57, v247, v27, v57
s_waitcnt vmcnt(5)
s_add_u32 s42, s41, 147456
s_and_b32 s42, s42, 0xfffff
buffer_load_dwordx4 v[144:147], v2, s[64:67], s42 offen offset:0 nt
v_dot2_f32_bf16 v58, v248, v24, 0
v_dot2_f32_bf16 v58, v249, v25, v58
v_dot2_f32_bf16 v58, v250, v26, v58
v_dot2_f32_bf16 v58, v251, v27, v58
s_waitcnt vmcnt(5)
buffer_load_dwordx4 v[148:151], v2, s[64:67], s42 offen offset:1024 nt
v_dot2_f32_bf16 v59, v252, v24, 0
v_dot2_f32_bf16 v59, v253, v25, v59
v_dot2_f32_bf16 v59, v254, v26, v59
v_dot2_f32_bf16 v59, v255, v27, v59
s_add_u32 s41, s41, 131072
s_waitcnt lgkmcnt(0)
v_mov_b32 v3, 11048
v_mov_b32 v127, 1
s_mov_b64 exec, 1
ds_add_u32 v3, v127
s_mov_b64 exec, -1
s_mov_b32 s43, 6
L_kloop:
s_waitcnt vmcnt(5)
v_dot2_f32_bf16 v28, v128, v24, 0
v_dot2_f32_bf16 v28, v129, v25, v28
v_dot2_f32_bf16 v28, v130, v26, v28
v_dot2_f32_bf16 v28, v131, v27, v28
v_add_f32_dpp v44, v44, v44 row_ror:8 row_mask:0xf bank_mask:0x3
v_add_f32_dpp v45, v45, v45 row_ror:8 row_mask:0xf bank_mask:0x3
v_add_f32_dpp v46, v46, v46 row_ror:8 row_mask:0xf bank_mask:0x3
v_add_f32_dpp v47, v47, v47 row_ror:8 row_mask:0xf bank_mask:0x3
s_waitcnt vmcnt(4)
s_add_u32 s42, s41, 16384
s_and_b32 s42, s42, 0xfffff
buffer_load_dwordx4 v[152:155], v2, s[64:67], s42 offen offset:2048 nt
v_dot2_f32_bf16 v29, v132, v24, 0
v_dot2_f32_bf16 v29, v133, v25, v29
v_dot2_f32_bf16 v29, v134, v26, v29
v_dot2_f32_bf16 v29, v135, v27, v29
v_add_f32_dpp v48, v48, v48 row_ror:8 row_mask:0xf bank_mask:0x3
v_add_f32_dpp v49, v49, v49 row_ror:8 row_mask:0xf bank_mask:0x3
v_add_f32_dpp v50, v50, v50 row_ror:8 row_mask:0xf bank_mask:0x3
v_add_f32_dpp v51, v51, v51 row_ror:8 row_mask:0xf bank_mask:0x3
s_waitcnt vmcnt(4)
buffer_load_dwordx4 v[156:159], v2, s[64:67], s42 offen offset:3072 nt
s_add_u32 s42, s41, 32768
s_and_b32 s42, s42, 0xfffff
buffer_load_dwordx4 v[160:163], v2, s[64:67], s42 offen offset:0 nt
v_dot2_f32_bf16 v30, v136, v24, 0
v_dot2_f32_bf16 v30, v137, v25, v30
v_dot2_f32_bf16 v30, v138, v26, v30
v_dot2_f32_bf16 v30, v139, v27, v30
v_add_f32_dpp v44, v52, v52 row_ror:8 row_mask:0xf bank_mask:0xc
v_add_f32_dpp v45, v53, v53 row_ror:8 row_mask:0xf bank_mask:0xc
v_add_f32_dpp v46, v54, v54 row_ror:8 row_mask:0xf bank_mask:0xc
v_add_f32_dpp v47, v55, v55 row_ror:8 row_mask:0xf bank_mask:0xc
s_waitcnt vmcnt(5)
buffer_load_dwordx4 v[164:167], v2, s[64:67], s42 offen offset:1024 nt
v_dot2_f32_bf16 v31, v140, v24, 0
v_dot2_f32_bf16 v31, v141, v25, v31
v_dot2_f32_bf16 v31, v142, v26, v31
v_dot2_f32_bf16 v31, v143, v27, v31
v_add_f32_dpp v48, v56, v56 row_ror:8 row_mask:0xf bank_mask:0xc
v_add_f32_dpp v49, v57, v57 row_ror:8 row_mask:0xf bank_mask:0xc
v_add_f32_dpp v50, v58, v58 row_ror:8 row_mask:0xf bank_mask:0xc
v_add_f32_dpp v51, v59, v59 row_ror:8 row_mask:0xf bank_mask:0xc
s_waitcnt vmcnt(5)
v_dot2_f32_bf16 v32, v144, v24, 0
v_dot2_f32_bf16 v32, v145, v25, v32
v_dot2_f32_bf16 v32, v146, v26, v32
v_dot2_f32_bf16 v32, v147, v27, v32
v_add_f32_dpp v44, v44, v44 row_shl:4 row_mask:0xf bank_mask:0x5
v_add_f32_dpp v45, v45, v45 row_shl:4 row_mask:0xf bank_mask:0x5
v_add_f32_dpp v46, v46, v46 row_shl:4 row_mask:0xf bank_mask:0x5
v_add_f32_dpp v47, v47, v47 row_shl:4 row_mask:0xf bank_mask:0x5
s_waitcnt vmcnt(4)
buffer_load_dwordx4 v[168:171], v2, s[64:67], s42 offen offset:2048 nt
v_dot2_f32_bf16 v33, v148, v24, 0
v_dot2_f32_bf16 v33, v149, v25, v33
v_dot2_f32_bf16 v33, v150, v26, v33
v_dot2_f32_bf16 v33, v151, v27, v33
v_add_f32_dpp v44, v48, v48 row_shr:4 row_mask:0xf bank_mask:0xa
v_add_f32_dpp v45, v49, v49 row_shr:4 row_mask:0xf bank_mask:0xa
v_add_f32_dpp v46, v50, v50 row_shr:4 row_mask:0xf bank_mask:0xa
v_add_f32_dpp v47, v51, v51 row_shr:4 row_mask:0xf bank_mask:0xa
s_waitcnt vmcnt(4)
buffer_load_dwordx4 v[172:175], v2, s[64:67], s42 offen offset:3072 nt
s_add_u32 s42, s41, 49152
s_and_b32 s42, s42, 0xfffff
buffer_load_dwordx4 v[176:179], v2, s[64:67], s42 offen offset:0 nt
v_dot2_f32_bf16 v34, v152, v24, 0
v_dot2_f32_bf16 v34, v153, v25, v34
v_dot2_f32_bf16 v34, v154, v26, v34
v_dot2_f32_bf16 v34, v155, v27, v34
v_add_f32_dpp v52, v44, v44 quad_perm:[2,3,0,1] row_mask:0xf bank_mask:0xf
v_add_f32_dpp v53, v45, v45 quad_perm:[2,3,0,1] row_mask:0xf bank_mask:0xf
v_add_f32_dpp v54, v46, v46 quad_perm:[2,3,0,1] row_mask:0xf bank_mask:0xf
v_add_f32_dpp v55, v47, v47 quad_perm:[2,3,0,1] row_mask:0xf bank_mask:0xf
s_waitcnt vmcnt(5)
buffer_load_dwordx4 v[180:183], v2, s[64:67], s42 offen offset:1024 nt
v_dot2_f32_bf16 v35, v156, v24, 0
v_dot2_f32_bf16 v35, v157, v25, v35
v_dot2_f32_bf16 v35, v158, v26, v35
v_dot2_f32_bf16 v35, v159, v27, v35
v_cndmask_b32 v44, v52, v54, s[48:49]
v_cndmask_b32 v45, v53, v55, s[48:49]
s_nop 0
v_add_f32_dpp v52, v44, v44 quad_perm:[1,0,3,2] row_mask:0xf bank_mask:0xf
v_add_f32_dpp v53, v45, v45 quad_perm:[1,0,3,2] row_mask:0xf bank_mask:0xf
s_waitcnt vmcnt(5)
v_dot2_f32_bf16 v36, v160, v24, 0
v_dot2_f32_bf16 v36, v161, v25, v36
v_dot2_f32_bf16 v36, v162, v26, v36
v_dot2_f32_bf16 v36, v163, v27, v36
v_cndmask_b32 v87, v52, v53, s[46:47]
v_cvt_pk_bf16_f32 v87, v87, v87
v_and_b32 v87, 0xffff0000, v87
v_mul_f32 v87, 0x3db504f3, v87
s_waitcnt vmcnt(4)
buffer_load_dwordx4 v[184:187], v2, s[64:67], s42 offen offset:2048 nt
v_dot2_f32_bf16 v37, v164, v24, 0
v_dot2_f32_bf16 v37, v165, v25, v37
v_dot2_f32_bf16 v37, v166, v26, v37
v_dot2_f32_bf16 v37, v167, v27, v37
v_cvt_pk_bf16_f32 v87, v87, v87
v_and_b32 v87, 0xffff0000, v87
ds_write_b32 v86, v87 offset:24064
v_max_f32 v88, v85, v87
s_waitcnt vmcnt(4)
buffer_load_dwordx4 v[188:191], v2, s[64:67], s42 offen offset:3072 nt
s_add_u32 s42, s41, 65536
s_and_b32 s42, s42, 0xfffff
buffer_load_dwordx4 v[128:131], v2, s[64:67], s42 offen offset:0 nt
v_dot2_f32_bf16 v38, v168, v24, 0
v_dot2_f32_bf16 v38, v169, v25, v38
v_dot2_f32_bf16 v38, v170, v26, v38
v_dot2_f32_bf16 v38, v171, v27, v38
v_sub_f32 v90, v85, v88
v_sub_f32 v91, v87, v88
v_mul_f32 v90, 0x3fb8aa3b, v90
v_mul_f32 v91, 0x3fb8aa3b, v91
s_waitcnt vmcnt(5)
buffer_load_dwordx4 v[132:135], v2, s[64:67], s42 offen offset:1024 nt
v_dot2_f32_bf16 v39, v172, v24, 0
v_dot2_f32_bf16 v39, v173, v25, v39
v_dot2_f32_bf16 v39, v174, v26, v39
v_dot2_f32_bf16 v39, v175, v27, v39
v_exp_f32 v90, v90
v_exp_f32 v91, v91
v_mov_b32 v85, v88
v_add_u32 v86, 256, v86
s_waitcnt vmcnt(5)
v_dot2_f32_bf16 v40, v176, v24, 0
v_dot2_f32_bf16 v40, v177, v25, v40
v_dot2_f32_bf16 v40, v178, v26, v40
v_dot2_f32_bf16 v40, v179, v27, v40
v_fma_f32 v89, v89, v90, v91
s_waitcnt vmcnt(4)
buffer_load_dwordx4 v[136:139], v2, s[64:67], s42 offen offset:2048 nt
v_dot2_f32_bf16 v41, v180, v24, 0
v_dot2_f32_bf16 v41, v181, v25, v41
v_dot2_f32_bf16 v41, v182, v26, v41
v_dot2_f32_bf16 v41, v183, v27, v41
s_waitcnt vmcnt(4)
buffer_load_dwordx4 v[140:143], v2, s[64:67], s42 offen offset:3072 nt
s_add_u32 s42, s41, 81920
s_and_b32 s42, s42, 0xfffff
buffer_load_dwordx4 v[144:147], v2, s[64:67], s42 offen offset:0 nt
v_dot2_f32_bf16 v42, v184, v24, 0
v_dot2_f32_bf16 v42, v185, v25, v42
v_dot2_f32_bf16 v42, v186, v26, v42
v_dot2_f32_bf16 v42, v187, v27, v42
s_waitcnt vmcnt(5)
buffer_load_dwordx4 v[148:151], v2, s[64:67], s42 offen offset:1024 nt
v_dot2_f32_bf16 v43, v188, v24, 0
v_dot2_f32_bf16 v43, v189, v25, v43
v_dot2_f32_bf16 v43, v190, v26, v43
v_dot2_f32_bf16 v43, v191, v27, v43
s_waitcnt vmcnt(5)
v_dot2_f32_bf16 v44, v128, v24, 0
v_dot2_f32_bf16 v44, v129, v25, v44
v_dot2_f32_bf16 v44, v130, v26, v44
v_dot2_f32_bf16 v44, v131, v27, v44
v_add_f32_dpp v28, v28, v28 row_ror:8 row_mask:0xf bank_mask:0x3
v_add_f32_dpp v29, v29, v29 row_ror:8 row_mask:0xf bank_mask:0x3
v_add_f32_dpp v30, v30, v30 row_ror:8 row_mask:0xf bank_mask:0x3
v_add_f32_dpp v31, v31, v31 row_ror:8 row_mask:0xf bank_mask:0x3
s_waitcnt vmcnt(4)
buffer_load_dwordx4 v[152:155], v2, s[64:67], s42 offen offset:2048 nt
v_dot2_f32_bf16 v45, v132, v24, 0
v_dot2_f32_bf16 v45, v133, v25, v45
v_dot2_f32_bf16 v45, v134, v26, v45
v_dot2_f32_bf16 v45, v135, v27, v45
v_add_f32_dpp v32, v32, v32 row_ror:8 row_mask:0xf bank_mask:0x3
v_add_f32_dpp v33, v33, v33 row_ror:8 row_mask:0xf bank_mask:0x3
v_add_f32_dpp v34, v34, v34 row_ror:8 row_mask:0xf bank_mask:0x3
v_add_f32_dpp v35, v35, v35 row_ror:8 row_mask:0xf bank_mask:0x3
s_waitcnt vmcnt(4)
buffer_load_dwordx4 v[156:159], v2, s[64:67], s42 offen offset:3072 nt
s_add_u32 s42, s41, 98304
s_and_b32 s42, s42, 0xfffff
buffer_load_dwordx4 v[160:163], v2, s[64:67], s42 offen offset:0 nt
v_dot2_f32_bf16 v46, v136, v24, 0
v_dot2_f32_bf16 v46, v137, v25, v46
v_dot2_f32_bf16 v46, v138, v26, v46
v_dot2_f32_bf16 v46, v139, v27, v46
v_add_f32_dpp v28, v36, v36 row_ror:8 row_mask:0xf bank_mask:0xc
v_add_f32_dpp v29, v37, v37 row_ror:8 row_mask:0xf bank_mask:0xc
v_add_f32_dpp v30, v38, v38 row_ror:8 row_mask:0xf bank_mask:0xc
v_add_f32_dpp v31, v39, v39 row_ror:8 row_mask:0xf bank_mask:0xc
s_waitcnt vmcnt(5)
buffer_load_dwordx4 v[164:167], v2, s[64:67], s42 offen offset:1024 nt
v_dot2_f32_bf16 v47, v140, v24, 0
v_dot2_f32_bf16 v47, v141, v25, v47
v_dot2_f32_bf16 v47, v142, v26, v47
v_dot2_f32_bf16 v47, v143, v27, v47
v_add_f32_dpp v32, v40, v40 row_ror:8 row_mask:0xf bank_mask:0xc
v_add_f32_dpp v33, v41, v41 row_ror:8 row_mask:0xf bank_mask:0xc
v_add_f32_dpp v34, v42, v42 row_ror:8 row_mask:0xf bank_mask:0xc
v_add_f32_dpp v35, v43, v43 row_ror:8 row_mask:0xf bank_mask:0xc
s_waitcnt vmcnt(5)
v_dot2_f32_bf16 v48, v144, v24, 0
v_dot2_f32_bf16 v48, v145, v25, v48
v_dot2_f32_bf16 v48, v146, v26, v48
v_dot2_f32_bf16 v48, v147, v27, v48
v_add_f32_dpp v28, v28, v28 row_shl:4 row_mask:0xf bank_mask:0x5
v_add_f32_dpp v29, v29, v29 row_shl:4 row_mask:0xf bank_mask:0x5
v_add_f32_dpp v30, v30, v30 row_shl:4 row_mask:0xf bank_mask:0x5
v_add_f32_dpp v31, v31, v31 row_shl:4 row_mask:0xf bank_mask:0x5
s_waitcnt vmcnt(4)
buffer_load_dwordx4 v[168:171], v2, s[64:67], s42 offen offset:2048 nt
v_dot2_f32_bf16 v49, v148, v24, 0
v_dot2_f32_bf16 v49, v149, v25, v49
v_dot2_f32_bf16 v49, v150, v26, v49
v_dot2_f32_bf16 v49, v151, v27, v49
v_add_f32_dpp v28, v32, v32 row_shr:4 row_mask:0xf bank_mask:0xa
v_add_f32_dpp v29, v33, v33 row_shr:4 row_mask:0xf bank_mask:0xa
v_add_f32_dpp v30, v34, v34 row_shr:4 row_mask:0xf bank_mask:0xa
v_add_f32_dpp v31, v35, v35 row_shr:4 row_mask:0xf bank_mask:0xa
s_waitcnt vmcnt(4)
buffer_load_dwordx4 v[172:175], v2, s[64:67], s42 offen offset:3072 nt
s_add_u32 s42, s41, 114688
s_and_b32 s42, s42, 0xfffff
buffer_load_dwordx4 v[176:179], v2, s[64:67], s42 offen offset:0 nt
v_dot2_f32_bf16 v50, v152, v24, 0
v_dot2_f32_bf16 v50, v153, v25, v50
v_dot2_f32_bf16 v50, v154, v26, v50
v_dot2_f32_bf16 v50, v155, v27, v50
v_add_f32_dpp v36, v28, v28 quad_perm:[2,3,0,1] row_mask:0xf bank_mask:0xf
v_add_f32_dpp v37, v29, v29 quad_perm:[2,3,0,1] row_mask:0xf bank_mask:0xf
v_add_f32_dpp v38, v30, v30 quad_perm:[2,3,0,1] row_mask:0xf bank_mask:0xf
v_add_f32_dpp v39, v31, v31 quad_perm:[2,3,0,1] row_mask:0xf bank_mask:0xf
s_waitcnt vmcnt(5)
buffer_load_dwordx4 v[180:183], v2, s[64:67], s42 offen offset:1024 nt
v_dot2_f32_bf16 v51, v156, v24, 0
v_dot2_f32_bf16 v51, v157, v25, v51
v_dot2_f32_bf16 v51, v158, v26, v51
v_dot2_f32_bf16 v51, v159, v27, v51
v_cndmask_b32 v28, v36, v38, s[48:49]
v_cndmask_b32 v29, v37, v39, s[48:49]
s_nop 0
v_add_f32_dpp v36, v28, v28 quad_perm:[1,0,3,2] row_mask:0xf bank_mask:0xf
v_add_f32_dpp v37, v29, v29 quad_perm:[1,0,3,2] row_mask:0xf bank_mask:0xf
s_waitcnt vmcnt(5)
v_dot2_f32_bf16 v52, v160, v24, 0
v_dot2_f32_bf16 v52, v161, v25, v52
v_dot2_f32_bf16 v52, v162, v26, v52
v_dot2_f32_bf16 v52, v163, v27, v52
v_cndmask_b32 v87, v36, v37, s[46:47]
v_cvt_pk_bf16_f32 v87, v87, v87
v_and_b32 v87, 0xffff0000, v87
v_mul_f32 v87, 0x3db504f3, v87
s_waitcnt vmcnt(4)
buffer_load_dwordx4 v[184:187], v2, s[64:67], s42 offen offset:2048 nt
v_dot2_f32_bf16 v53, v164, v24, 0
v_dot2_f32_bf16 v53, v165, v25, v53
v_dot2_f32_bf16 v53, v166, v26, v53
v_dot2_f32_bf16 v53, v167, v27, v53
v_cvt_pk_bf16_f32 v87, v87, v87
v_and_b32 v87, 0xffff0000, v87
ds_write_b32 v86, v87 offset:24064
v_max_f32 v88, v85, v87
s_waitcnt vmcnt(4)
buffer_load_dwordx4 v[188:191], v2, s[64:67], s42 offen offset:3072 nt
s_add_u32 s42, s41, 131072
s_and_b32 s42, s42, 0xfffff
buffer_load_dwordx4 v[128:131], v2, s[64:67], s42 offen offset:0 nt
v_dot2_f32_bf16 v54, v168, v24, 0
v_dot2_f32_bf16 v54, v169, v25, v54
v_dot2_f32_bf16 v54, v170, v26, v54
v_dot2_f32_bf16 v54, v171, v27, v54
v_sub_f32 v90, v85, v88
v_sub_f32 v91, v87, v88
v_mul_f32 v90, 0x3fb8aa3b, v90
v_mul_f32 v91, 0x3fb8aa3b, v91
s_waitcnt vmcnt(5)
buffer_load_dwordx4 v[132:135], v2, s[64:67], s42 offen offset:1024 nt
v_dot2_f32_bf16 v55, v172, v24, 0
v_dot2_f32_bf16 v55, v173, v25, v55
v_dot2_f32_bf16 v55, v174, v26, v55
v_dot2_f32_bf16 v55, v175, v27, v55
v_exp_f32 v90, v90
v_exp_f32 v91, v91
v_mov_b32 v85, v88
v_add_u32 v86, 256, v86
s_waitcnt vmcnt(5)
v_dot2_f32_bf16 v56, v176, v24, 0
v_dot2_f32_bf16 v56, v177, v25, v56
v_dot2_f32_bf16 v56, v178, v26, v56
v_dot2_f32_bf16 v56, v179, v27, v56
v_fma_f32 v89, v89, v90, v91
s_waitcnt vmcnt(4)
buffer_load_dwordx4 v[136:139], v2, s[64:67], s42 offen offset:2048 nt
v_dot2_f32_bf16 v57, v180, v24, 0
v_dot2_f32_bf16 v57, v181, v25, v57
v_dot2_f32_bf16 v57, v182, v26, v57
v_dot2_f32_bf16 v57, v183, v27, v57
s_waitcnt vmcnt(4)
buffer_load_dwordx4 v[140:143], v2, s[64:67], s42 offen offset:3072 nt
s_add_u32 s42, s41, 147456
s_and_b32 s42, s42, 0xfffff
buffer_load_dwordx4 v[144:147], v2, s[64:67], s42 offen offset:0 nt
v_dot2_f32_bf16 v58, v184, v24, 0
v_dot2_f32_bf16 v58, v185, v25, v58
v_dot2_f32_bf16 v58, v186, v26, v58
v_dot2_f32_bf16 v58, v187, v27, v58
s_waitcnt vmcnt(5)
buffer_load_dwordx4 v[148:151], v2, s[64:67], s42 offen offset:1024 nt
v_dot2_f32_bf16 v59, v188, v24, 0
v_dot2_f32_bf16 v59, v189, v25, v59
v_dot2_f32_bf16 v59, v190, v26, v59
v_dot2_f32_bf16 v59, v191, v27, v59
s_waitcnt lgkmcnt(0)
v_mov_b32 v3, 11048
v_mov_b32 v127, 1
s_mov_b64 exec, 1
ds_add_u32 v3, v127
s_mov_b64 exec, -1
s_add_u32 s41, s41, 131072
s_sub_u32 s43, s43, 1
s_cmp_lg_u32 s43, 0
s_cbranch_scc1 L_kloop
L_kloop_end:
s_waitcnt vmcnt(5)
s_add_u32 s42, s41, 16384
s_and_b32 s42, s42, 0xfffff
buffer_load_dwordx4 v[152:155], v2, s[64:67], s42 offen offset:2048 nt
v_dot2_f32_bf16 v28, v128, v24, 0
v_dot2_f32_bf16 v28, v129, v25, v28
v_dot2_f32_bf16 v28, v130, v26, v28
v_dot2_f32_bf16 v28, v131, v27, v28
v_add_f32_dpp v44, v44, v44 row_ror:8 row_mask:0xf bank_mask:0x3
v_add_f32_dpp v45, v45, v45 row_ror:8 row_mask:0xf bank_mask:0x3
v_add_f32_dpp v46, v46, v46 row_ror:8 row_mask:0xf bank_mask:0x3
v_add_f32_dpp v47, v47, v47 row_ror:8 row_mask:0xf bank_mask:0x3
s_waitcnt vmcnt(5)
buffer_load_dwordx4 v[156:159], v2, s[64:67], s42 offen offset:3072 nt
v_dot2_f32_bf16 v29, v132, v24, 0
v_dot2_f32_bf16 v29, v133, v25, v29
v_dot2_f32_bf16 v29, v134, v26, v29
v_dot2_f32_bf16 v29, v135, v27, v29
v_add_f32_dpp v48, v48, v48 row_ror:8 row_mask:0xf bank_mask:0x3
v_add_f32_dpp v49, v49, v49 row_ror:8 row_mask:0xf bank_mask:0x3
v_add_f32_dpp v50, v50, v50 row_ror:8 row_mask:0xf bank_mask:0x3
v_add_f32_dpp v51, v51, v51 row_ror:8 row_mask:0xf bank_mask:0x3
s_waitcnt vmcnt(5)
s_add_u32 s42, s41, 32768
s_and_b32 s42, s42, 0xfffff
buffer_load_dwordx4 v[160:163], v2, s[64:67], s42 offen offset:0 nt
v_dot2_f32_bf16 v30, v136, v24, 0
v_dot2_f32_bf16 v30, v137, v25, v30
v_dot2_f32_bf16 v30, v138, v26, v30
v_dot2_f32_bf16 v30, v139, v27, v30
v_add_f32_dpp v44, v52, v52 row_ror:8 row_mask:0xf bank_mask:0xc
v_add_f32_dpp v45, v53, v53 row_ror:8 row_mask:0xf bank_mask:0xc
v_add_f32_dpp v46, v54, v54 row_ror:8 row_mask:0xf bank_mask:0xc
v_add_f32_dpp v47, v55, v55 row_ror:8 row_mask:0xf bank_mask:0xc
s_waitcnt vmcnt(5)
buffer_load_dwordx4 v[164:167], v2, s[64:67], s42 offen offset:1024 nt
v_dot2_f32_bf16 v31, v140, v24, 0
v_dot2_f32_bf16 v31, v141, v25, v31
v_dot2_f32_bf16 v31, v142, v26, v31
v_dot2_f32_bf16 v31, v143, v27, v31
v_add_f32_dpp v48, v56, v56 row_ror:8 row_mask:0xf bank_mask:0xc
v_add_f32_dpp v49, v57, v57 row_ror:8 row_mask:0xf bank_mask:0xc
v_add_f32_dpp v50, v58, v58 row_ror:8 row_mask:0xf bank_mask:0xc
v_add_f32_dpp v51, v59, v59 row_ror:8 row_mask:0xf bank_mask:0xc
s_waitcnt vmcnt(5)
buffer_load_dwordx4 v[168:171], v2, s[64:67], s42 offen offset:2048 nt
v_dot2_f32_bf16 v32, v144, v24, 0
v_dot2_f32_bf16 v32, v145, v25, v32
v_dot2_f32_bf16 v32, v146, v26, v32
v_dot2_f32_bf16 v32, v147, v27, v32
v_add_f32_dpp v44, v44, v44 row_shl:4 row_mask:0xf bank_mask:0x5
v_add_f32_dpp v45, v45, v45 row_shl:4 row_mask:0xf bank_mask:0x5
v_add_f32_dpp v46, v46, v46 row_shl:4 row_mask:0xf bank_mask:0x5
v_add_f32_dpp v47, v47, v47 row_shl:4 row_mask:0xf bank_mask:0x5
s_waitcnt vmcnt(5)
buffer_load_dwordx4 v[172:175], v2, s[64:67], s42 offen offset:3072 nt
v_dot2_f32_bf16 v33, v148, v24, 0
v_dot2_f32_bf16 v33, v149, v25, v33
v_dot2_f32_bf16 v33, v150, v26, v33
v_dot2_f32_bf16 v33, v151, v27, v33
v_add_f32_dpp v44, v48, v48 row_shr:4 row_mask:0xf bank_mask:0xa
v_add_f32_dpp v45, v49, v49 row_shr:4 row_mask:0xf bank_mask:0xa
v_add_f32_dpp v46, v50, v50 row_shr:4 row_mask:0xf bank_mask:0xa
v_add_f32_dpp v47, v51, v51 row_shr:4 row_mask:0xf bank_mask:0xa
s_waitcnt vmcnt(5)
s_add_u32 s42, s41, 49152
s_and_b32 s42, s42, 0xfffff
buffer_load_dwordx4 v[176:179], v2, s[64:67], s42 offen offset:0 nt
v_dot2_f32_bf16 v34, v152, v24, 0
v_dot2_f32_bf16 v34, v153, v25, v34
v_dot2_f32_bf16 v34, v154, v26, v34
v_dot2_f32_bf16 v34, v155, v27, v34
v_add_f32_dpp v52, v44, v44 quad_perm:[2,3,0,1] row_mask:0xf bank_mask:0xf
v_add_f32_dpp v53, v45, v45 quad_perm:[2,3,0,1] row_mask:0xf bank_mask:0xf
v_add_f32_dpp v54, v46, v46 quad_perm:[2,3,0,1] row_mask:0xf bank_mask:0xf
v_add_f32_dpp v55, v47, v47 quad_perm:[2,3,0,1] row_mask:0xf bank_mask:0xf
s_waitcnt vmcnt(5)
buffer_load_dwordx4 v[180:183], v2, s[64:67], s42 offen offset:1024 nt
v_dot2_f32_bf16 v35, v156, v24, 0
v_dot2_f32_bf16 v35, v157, v25, v35
v_dot2_f32_bf16 v35, v158, v26, v35
v_dot2_f32_bf16 v35, v159, v27, v35
v_cndmask_b32 v44, v52, v54, s[48:49]
v_cndmask_b32 v45, v53, v55, s[48:49]
s_nop 0
v_add_f32_dpp v52, v44, v44 quad_perm:[1,0,3,2] row_mask:0xf bank_mask:0xf
v_add_f32_dpp v53, v45, v45 quad_perm:[1,0,3,2] row_mask:0xf bank_mask:0xf
s_waitcnt vmcnt(5)
buffer_load_dwordx4 v[184:187], v2, s[64:67], s42 offen offset:2048 nt
v_dot2_f32_bf16 v36, v160, v24, 0
v_dot2_f32_bf16 v36, v161, v25, v36
v_dot2_f32_bf16 v36, v162, v26, v36
v_dot2_f32_bf16 v36, v163, v27, v36
v_cndmask_b32 v87, v52, v53, s[46:47]
v_cvt_pk_bf16_f32 v87, v87, v87
v_and_b32 v87, 0xffff0000, v87
v_mul_f32 v87, 0x3db504f3, v87
s_waitcnt vmcnt(5)
buffer_load_dwordx4 v[188:191], v2, s[64:67], s42 offen offset:3072 nt
v_dot2_f32_bf16 v37, v164, v24, 0
v_dot2_f32_bf16 v37, v165, v25, v37
v_dot2_f32_bf16 v37, v166, v26, v37
v_dot2_f32_bf16 v37, v167, v27, v37
v_cvt_pk_bf16_f32 v87, v87, v87
v_and_b32 v87, 0xffff0000, v87
ds_write_b32 v86, v87 offset:24064
v_max_f32 v88, v85, v87
s_waitcnt vmcnt(5)
s_add_u32 s42, s41, 65536
s_and_b32 s42, s42, 0xfffff
buffer_load_dwordx4 v[128:131], v2, s[64:67], s42 offen offset:0 nt
v_dot2_f32_bf16 v38, v168, v24, 0
v_dot2_f32_bf16 v38, v169, v25, v38
v_dot2_f32_bf16 v38, v170, v26, v38
v_dot2_f32_bf16 v38, v171, v27, v38
v_sub_f32 v90, v85, v88
v_sub_f32 v91, v87, v88
v_mul_f32 v90, 0x3fb8aa3b, v90
v_mul_f32 v91, 0x3fb8aa3b, v91
s_waitcnt vmcnt(5)
buffer_load_dwordx4 v[132:135], v2, s[64:67], s42 offen offset:1024 nt
v_dot2_f32_bf16 v39, v172, v24, 0
v_dot2_f32_bf16 v39, v173, v25, v39
v_dot2_f32_bf16 v39, v174, v26, v39
v_dot2_f32_bf16 v39, v175, v27, v39
v_exp_f32 v90, v90
v_exp_f32 v91, v91
v_mov_b32 v85, v88
v_add_u32 v86, 256, v86
s_waitcnt vmcnt(5)
buffer_load_dwordx4 v[136:139], v2, s[64:67], s42 offen offset:2048 nt
v_dot2_f32_bf16 v40, v176, v24, 0
v_dot2_f32_bf16 v40, v177, v25, v40
v_dot2_f32_bf16 v40, v178, v26, v40
v_dot2_f32_bf16 v40, v179, v27, v40
v_fma_f32 v89, v89, v90, v91
s_waitcnt vmcnt(5)
buffer_load_dwordx4 v[140:143], v2, s[64:67], s42 offen offset:3072 nt
v_dot2_f32_bf16 v41, v180, v24, 0
v_dot2_f32_bf16 v41, v181, v25, v41
v_dot2_f32_bf16 v41, v182, v26, v41
v_dot2_f32_bf16 v41, v183, v27, v41
s_waitcnt vmcnt(5)
s_add_u32 s42, s41, 81920
s_and_b32 s42, s42, 0xfffff
buffer_load_dwordx4 v[144:147], v2, s[64:67], s42 offen offset:0 nt
v_dot2_f32_bf16 v42, v184, v24, 0
v_dot2_f32_bf16 v42, v185, v25, v42
v_dot2_f32_bf16 v42, v186, v26, v42
v_dot2_f32_bf16 v42, v187, v27, v42
s_waitcnt vmcnt(5)
buffer_load_dwordx4 v[148:151], v2, s[64:67], s42 offen offset:1024 nt
v_dot2_f32_bf16 v43, v188, v24, 0
v_dot2_f32_bf16 v43, v189, v25, v43
v_dot2_f32_bf16 v43, v190, v26, v43
v_dot2_f32_bf16 v43, v191, v27, v43
s_add_u32 s41, s41, 65536
s_lshl_b32 s37, s3, 12
s_add_u32 s39, s44, s37
s_waitcnt vmcnt(5)
s_add_u32 s42, s41, 16384
s_and_b32 s42, s42, 0xfffff
buffer_load_dwordx4 v[152:155], v2, s[64:67], s42 offen offset:2048 nt
v_dot2_f32_bf16 v44, v128, v24, 0
v_dot2_f32_bf16 v44, v129, v25, v44
v_dot2_f32_bf16 v44, v130, v26, v44
v_dot2_f32_bf16 v44, v131, v27, v44
v_add_f32_dpp v28, v28, v28 row_ror:8 row_mask:0xf bank_mask:0x3
v_add_f32_dpp v29, v29, v29 row_ror:8 row_mask:0xf bank_mask:0x3
v_add_f32_dpp v30, v30, v30 row_ror:8 row_mask:0xf bank_mask:0x3
v_add_f32_dpp v31, v31, v31 row_ror:8 row_mask:0xf bank_mask:0x3
s_waitcnt vmcnt(5)
buffer_load_dwordx4 v[156:159], v2, s[64:67], s42 offen offset:3072 nt
v_dot2_f32_bf16 v45, v132, v24, 0
v_dot2_f32_bf16 v45, v133, v25, v45
v_dot2_f32_bf16 v45, v134, v26, v45
v_dot2_f32_bf16 v45, v135, v27, v45
v_add_f32_dpp v32, v32, v32 row_ror:8 row_mask:0xf bank_mask:0x3
v_add_f32_dpp v33, v33, v33 row_ror:8 row_mask:0xf bank_mask:0x3
v_add_f32_dpp v34, v34, v34 row_ror:8 row_mask:0xf bank_mask:0x3
v_add_f32_dpp v35, v35, v35 row_ror:8 row_mask:0xf bank_mask:0x3
s_waitcnt vmcnt(5)
s_add_u32 s42, s41, 32768
s_and_b32 s42, s42, 0xfffff
buffer_load_dwordx4 v[160:163], v2, s[64:67], s42 offen offset:0 nt
v_dot2_f32_bf16 v46, v136, v24, 0
v_dot2_f32_bf16 v46, v137, v25, v46
v_dot2_f32_bf16 v46, v138, v26, v46
v_dot2_f32_bf16 v46, v139, v27, v46
v_add_f32_dpp v28, v36, v36 row_ror:8 row_mask:0xf bank_mask:0xc
v_add_f32_dpp v29, v37, v37 row_ror:8 row_mask:0xf bank_mask:0xc
v_add_f32_dpp v30, v38, v38 row_ror:8 row_mask:0xf bank_mask:0xc
v_add_f32_dpp v31, v39, v39 row_ror:8 row_mask:0xf bank_mask:0xc
s_waitcnt vmcnt(5)
buffer_load_dwordx4 v[164:167], v2, s[64:67], s42 offen offset:1024 nt
v_dot2_f32_bf16 v47, v140, v24, 0
v_dot2_f32_bf16 v47, v141, v25, v47
v_dot2_f32_bf16 v47, v142, v26, v47
v_dot2_f32_bf16 v47, v143, v27, v47
v_add_f32_dpp v32, v40, v40 row_ror:8 row_mask:0xf bank_mask:0xc
v_add_f32_dpp v33, v41, v41 row_ror:8 row_mask:0xf bank_mask:0xc
v_add_f32_dpp v34, v42, v42 row_ror:8 row_mask:0xf bank_mask:0xc
v_add_f32_dpp v35, v43, v43 row_ror:8 row_mask:0xf bank_mask:0xc
s_waitcnt vmcnt(5)
buffer_load_dwordx4 v[168:171], v2, s[64:67], s42 offen offset:2048 nt
v_dot2_f32_bf16 v48, v144, v24, 0
v_dot2_f32_bf16 v48, v145, v25, v48
v_dot2_f32_bf16 v48, v146, v26, v48
v_dot2_f32_bf16 v48, v147, v27, v48
v_add_f32_dpp v28, v28, v28 row_shl:4 row_mask:0xf bank_mask:0x5
v_add_f32_dpp v29, v29, v29 row_shl:4 row_mask:0xf bank_mask:0x5
v_add_f32_dpp v30, v30, v30 row_shl:4 row_mask:0xf bank_mask:0x5
v_add_f32_dpp v31, v31, v31 row_shl:4 row_mask:0xf bank_mask:0x5
s_waitcnt vmcnt(5)
buffer_load_dwordx4 v[172:175], v2, s[64:67], s42 offen offset:3072 nt
v_dot2_f32_bf16 v49, v148, v24, 0
v_dot2_f32_bf16 v49, v149, v25, v49
v_dot2_f32_bf16 v49, v150, v26, v49
v_dot2_f32_bf16 v49, v151, v27, v49
v_add_f32_dpp v28, v32, v32 row_shr:4 row_mask:0xf bank_mask:0xa
v_add_f32_dpp v29, v33, v33 row_shr:4 row_mask:0xf bank_mask:0xa
v_add_f32_dpp v30, v34, v34 row_shr:4 row_mask:0xf bank_mask:0xa
v_add_f32_dpp v31, v35, v35 row_shr:4 row_mask:0xf bank_mask:0xa
s_waitcnt vmcnt(5)
s_add_u32 s42, s41, 49152
s_and_b32 s42, s42, 0xfffff
buffer_load_dwordx4 v[176:179], v2, s[64:67], s42 offen offset:0 nt
v_dot2_f32_bf16 v50, v152, v24, 0
v_dot2_f32_bf16 v50, v153, v25, v50
v_dot2_f32_bf16 v50, v154, v26, v50
v_dot2_f32_bf16 v50, v155, v27, v50
v_add_f32_dpp v36, v28, v28 quad_perm:[2,3,0,1] row_mask:0xf bank_mask:0xf
v_add_f32_dpp v37, v29, v29 quad_perm:[2,3,0,1] row_mask:0xf bank_mask:0xf
v_add_f32_dpp v38, v30, v30 quad_perm:[2,3,0,1] row_mask:0xf bank_mask:0xf
v_add_f32_dpp v39, v31, v31 quad_perm:[2,3,0,1] row_mask:0xf bank_mask:0xf
s_waitcnt vmcnt(5)
buffer_load_dwordx4 v[180:183], v2, s[64:67], s42 offen offset:1024 nt
v_dot2_f32_bf16 v51, v156, v24, 0
v_dot2_f32_bf16 v51, v157, v25, v51
v_dot2_f32_bf16 v51, v158, v26, v51
v_dot2_f32_bf16 v51, v159, v27, v51
v_cndmask_b32 v28, v36, v38, s[48:49]
v_cndmask_b32 v29, v37, v39, s[48:49]
s_nop 0
v_add_f32_dpp v36, v28, v28 quad_perm:[1,0,3,2] row_mask:0xf bank_mask:0xf
v_add_f32_dpp v37, v29, v29 quad_perm:[1,0,3,2] row_mask:0xf bank_mask:0xf
s_waitcnt vmcnt(5)
buffer_load_dwordx4 v[184:187], v2, s[64:67], s42 offen offset:2048 nt
v_dot2_f32_bf16 v52, v160, v24, 0
v_dot2_f32_bf16 v52, v161, v25, v52
v_dot2_f32_bf16 v52, v162, v26, v52
v_dot2_f32_bf16 v52, v163, v27, v52
v_cndmask_b32 v87, v36, v37, s[46:47]
v_cvt_pk_bf16_f32 v87, v87, v87
v_and_b32 v87, 0xffff0000, v87
v_mul_f32 v87, 0x3db504f3, v87
s_waitcnt vmcnt(5)
buffer_load_dwordx4 v[188:191], v2, s[64:67], s42 offen offset:3072 nt
v_dot2_f32_bf16 v53, v164, v24, 0
v_dot2_f32_bf16 v53, v165, v25, v53
v_dot2_f32_bf16 v53, v166, v26, v53
v_dot2_f32_bf16 v53, v167, v27, v53
v_cvt_pk_bf16_f32 v87, v87, v87
v_and_b32 v87, 0xffff0000, v87
ds_write_b32 v86, v87 offset:24064
v_max_f32 v88, v85, v87
s_waitcnt vmcnt(5)
s_mov_b32 s41, s39
s_and_b32 s42, s41, 0xfffff
buffer_load_dwordx4 v[128:131], v2, s[68:71], s42 offen offset:0 nt
v_dot2_f32_bf16 v54, v168, v24, 0
v_dot2_f32_bf16 v54, v169, v25, v54
v_dot2_f32_bf16 v54, v170, v26, v54
v_dot2_f32_bf16 v54, v171, v27, v54
v_sub_f32 v90, v85, v88
v_sub_f32 v91, v87, v88
v_mul_f32 v90, 0x3fb8aa3b, v90
v_mul_f32 v91, 0x3fb8aa3b, v91
s_waitcnt vmcnt(5)
buffer_load_dwordx4 v[132:135], v2, s[68:71], s42 offen offset:1024 nt
v_dot2_f32_bf16 v55, v172, v24, 0
v_dot2_f32_bf16 v55, v173, v25, v55
v_dot2_f32_bf16 v55, v174, v26, v55
v_dot2_f32_bf16 v55, v175, v27, v55
v_exp_f32 v90, v90
v_exp_f32 v91, v91
v_mov_b32 v85, v88
v_add_u32 v86, 256, v86
s_waitcnt vmcnt(5)
buffer_load_dwordx4 v[136:139], v2, s[68:71], s42 offen offset:2048 nt
v_dot2_f32_bf16 v56, v176, v24, 0
v_dot2_f32_bf16 v56, v177, v25, v56
v_dot2_f32_bf16 v56, v178, v26, v56
v_dot2_f32_bf16 v56, v179, v27, v56
v_fma_f32 v89, v89, v90, v91
s_waitcnt vmcnt(5)
buffer_load_dwordx4 v[140:143], v2, s[68:71], s42 offen offset:3072 nt
v_dot2_f32_bf16 v57, v180, v24, 0
v_dot2_f32_bf16 v57, v181, v25, v57
v_dot2_f32_bf16 v57, v182, v26, v57
v_dot2_f32_bf16 v57, v183, v27, v57
s_waitcnt vmcnt(5)
s_add_u32 s42, s41, 16384
s_and_b32 s42, s42, 0xfffff
buffer_load_dwordx4 v[144:147], v2, s[68:71], s42 offen offset:0 nt
v_dot2_f32_bf16 v58, v184, v24, 0
v_dot2_f32_bf16 v58, v185, v25, v58
v_dot2_f32_bf16 v58, v186, v26, v58
v_dot2_f32_bf16 v58, v187, v27, v58
s_waitcnt vmcnt(5)
buffer_load_dwordx4 v[148:151], v2, s[68:71], s42 offen offset:1024 nt
v_dot2_f32_bf16 v59, v188, v24, 0
v_dot2_f32_bf16 v59, v189, v25, v59
v_dot2_f32_bf16 v59, v190, v26, v59
v_dot2_f32_bf16 v59, v191, v27, v59
v_add_f32_dpp v44, v44, v44 row_ror:8 row_mask:0xf bank_mask:0x3
v_add_f32_dpp v45, v45, v45 row_ror:8 row_mask:0xf bank_mask:0x3
v_add_f32_dpp v46, v46, v46 row_ror:8 row_mask:0xf bank_mask:0x3
v_add_f32_dpp v47, v47, v47 row_ror:8 row_mask:0xf bank_mask:0x3
v_add_f32_dpp v48, v48, v48 row_ror:8 row_mask:0xf bank_mask:0x3
v_add_f32_dpp v49, v49, v49 row_ror:8 row_mask:0xf bank_mask:0x3
v_add_f32_dpp v50, v50, v50 row_ror:8 row_mask:0xf bank_mask:0x3
v_add_f32_dpp v51, v51, v51 row_ror:8 row_mask:0xf bank_mask:0x3
v_add_f32_dpp v44, v52, v52 row_ror:8 row_mask:0xf bank_mask:0xc
v_add_f32_dpp v45, v53, v53 row_ror:8 row_mask:0xf bank_mask:0xc
v_add_f32_dpp v46, v54, v54 row_ror:8 row_mask:0xf bank_mask:0xc
v_add_f32_dpp v47, v55, v55 row_ror:8 row_mask:0xf bank_mask:0xc
v_add_f32_dpp v48, v56, v56 row_ror:8 row_mask:0xf bank_mask:0xc
v_add_f32_dpp v49, v57, v57 row_ror:8 row_mask:0xf bank_mask:0xc
v_add_f32_dpp v50, v58, v58 row_ror:8 row_mask:0xf bank_mask:0xc
v_add_f32_dpp v51, v59, v59 row_ror:8 row_mask:0xf bank_mask:0xc
v_add_f32_dpp v44, v44, v44 row_shl:4 row_mask:0xf bank_mask:0x5
v_add_f32_dpp v45, v45, v45 row_shl:4 row_mask:0xf bank_mask:0x5
v_add_f32_dpp v46, v46, v46 row_shl:4 row_mask:0xf bank_mask:0x5
v_add_f32_dpp v47, v47, v47 row_shl:4 row_mask:0xf bank_mask:0x5
v_add_f32_dpp v44, v48, v48 row_shr:4 row_mask:0xf bank_mask:0xa
v_add_f32_dpp v45, v49, v49 row_shr:4 row_mask:0xf bank_mask:0xa
v_add_f32_dpp v46, v50, v50 row_shr:4 row_mask:0xf bank_mask:0xa
v_add_f32_dpp v47, v51, v51 row_shr:4 row_mask:0xf bank_mask:0xa
v_add_f32_dpp v52, v44, v44 quad_perm:[2,3,0,1] row_mask:0xf bank_mask:0xf
v_add_f32_dpp v53, v45, v45 quad_perm:[2,3,0,1] row_mask:0xf bank_mask:0xf
v_add_f32_dpp v54, v46, v46 quad_perm:[2,3,0,1] row_mask:0xf bank_mask:0xf
v_add_f32_dpp v55, v47, v47 quad_perm:[2,3,0,1] row_mask:0xf bank_mask:0xf
v_cndmask_b32 v44, v52, v54, s[48:49]
v_cndmask_b32 v45, v53, v55, s[48:49]
s_nop 0
v_add_f32_dpp v52, v44, v44 quad_perm:[1,0,3,2] row_mask:0xf bank_mask:0xf
v_add_f32_dpp v53, v45, v45 quad_perm:[1,0,3,2] row_mask:0xf bank_mask:0xf
v_cndmask_b32 v87, v52, v53, s[46:47]
v_cvt_pk_bf16_f32 v87, v87, v87
v_and_b32 v87, 0xffff0000, v87
v_mul_f32 v87, 0x3db504f3, v87
v_cvt_pk_bf16_f32 v87, v87, v87
v_and_b32 v87, 0xffff0000, v87
ds_write_b32 v86, v87 offset:24064
v_max_f32 v88, v85, v87
v_sub_f32 v90, v85, v88
v_sub_f32 v91, v87, v88
v_mul_f32 v90, 0x3fb8aa3b, v90
v_mul_f32 v91, 0x3fb8aa3b, v91
v_exp_f32 v90, v90
v_exp_f32 v91, v91
v_mov_b32 v85, v88
v_add_u32 v86, 256, v86
v_fma_f32 v89, v89, v90, v91
v_mov_b32 v88, v85
s_nop 1
v_max_f32_dpp v88, v88, v88 row_ror:8 row_mask:0xf bank_mask:0xf
s_nop 1
v_max_f32_dpp v88, v88, v88 row_ror:4 row_mask:0xf bank_mask:0xf
s_nop 1
v_max_f32_dpp v88, v88, v88 row_ror:2 row_mask:0xf bank_mask:0xf
s_nop 1
v_max_f32_dpp v88, v88, v88 row_ror:1 row_mask:0xf bank_mask:0xf
v_mov_b32 v90, v88
s_nop 1
v_permlane16_swap_b32 v88, v90
v_max_f32 v88, v88, v90
v_mov_b32 v90, v88
s_nop 1
v_permlane32_swap_b32 v88, v90
v_max_f32 v88, v88, v90
v_sub_f32 v90, v85, v88
v_mul_f32 v90, 0x3fb8aa3b, v90
v_exp_f32 v90, v90
s_nop 0
v_mul_f32 v89, v89, v90
s_nop 1
v_add_f32_dpp v89, v89, v89 row_ror:8 row_mask:0xf bank_mask:0xf
s_nop 1
v_add_f32_dpp v89, v89, v89 row_ror:4 row_mask:0xf bank_mask:0xf
s_nop 1
v_add_f32_dpp v89, v89, v89 row_ror:2 row_mask:0xf bank_mask:0xf
s_nop 1
v_add_f32_dpp v89, v89, v89 row_ror:1 row_mask:0xf bank_mask:0xf
v_mov_b32 v90, v89
s_nop 1
v_permlane16_swap_b32 v89, v90
v_add_f32 v89, v89, v90
v_mov_b32 v90, v89
s_nop 1
v_permlane32_swap_b32 v89, v90
v_add_f32 v89, v89, v90
v_mov_b32 v44, v88
v_mov_b32 v45, v89
s_lshl_b32 s37, s3, 3
v_mov_b32 v90, s37
s_mov_b64 exec, 1
ds_write_b64 v90, v[44:45] offset:19712
s_mov_b64 exec, -1
s_waitcnt lgkmcnt(0)
v_mov_b32 v3, 11028
v_mov_b32 v127, 1
s_mov_b64 exec, 1
ds_add_u32 v3, v127
s_mov_b64 exec, -1
s_waitcnt vmcnt(5)
s_add_u32 s42, s41, 16384
s_and_b32 s42, s42, 0xfffff
buffer_load_dwordx4 v[152:155], v2, s[68:71], s42 offen offset:2048 nt
s_waitcnt vmcnt(5)
buffer_load_dwordx4 v[156:159], v2, s[68:71], s42 offen offset:3072 nt
s_waitcnt vmcnt(5)
s_add_u32 s42, s41, 32768
s_and_b32 s42, s42, 0xfffff
buffer_load_dwordx4 v[160:163], v2, s[68:71], s42 offen offset:0 nt
s_waitcnt vmcnt(5)
buffer_load_dwordx4 v[164:167], v2, s[68:71], s42 offen offset:1024 nt
s_waitcnt vmcnt(5)
buffer_load_dwordx4 v[168:171], v2, s[68:71], s42 offen offset:2048 nt
s_waitcnt vmcnt(5)
buffer_load_dwordx4 v[172:175], v2, s[68:71], s42 offen offset:3072 nt
s_waitcnt vmcnt(5)
s_add_u32 s42, s41, 49152
s_and_b32 s42, s42, 0xfffff
buffer_load_dwordx4 v[176:179], v2, s[68:71], s42 offen offset:0 nt
s_waitcnt vmcnt(5)
buffer_load_dwordx4 v[180:183], v2, s[68:71], s42 offen offset:1024 nt
s_waitcnt vmcnt(5)
buffer_load_dwordx4 v[184:187], v2, s[68:71], s42 offen offset:2048 nt
s_waitcnt vmcnt(5)
buffer_load_dwordx4 v[188:191], v2, s[68:71], s42 offen offset:3072 nt
v_subrev_u32 v86, 4096, v86
ds_read_b32 v92, v86 offset:24064
v_mov_b32 v16, 0
v_mov_b32 v17, 0
v_mov_b32 v18, 0
v_mov_b32 v19, 0
v_mov_b32 v3, 11032
s_mov_b32 s51, 1600000
Lw_4:
ds_read_b32 v127, v3
s_waitcnt lgkmcnt(0)
v_readfirstlane_b32 s37, v127
s_nop 0
s_cmp_ge_u32 s37, 1
s_cbranch_scc1 Lw_4_ok
s_sub_u32 s51, s51, 1
s_cmp_lg_u32 s51, 0
s_cbranch_scc1 Lw_4
Lw_4_ok:
v_mov_b32 v90, 0
ds_read_b64 v[46:47], v90 offset:19744
s_waitcnt lgkmcnt(0)
v_sub_f32 v91, v92, v46
v_mul_f32 v91, 0x3fb8aa3b, v91
v_exp_f32 v91, v91
v_add_u32 v86, 256, v86
ds_read_b32 v92, v86 offset:24064
v_mul_f32 v91, v91, v47
v_cvt_pk_bf16_f32 v93, v91, v91
s_waitcnt vmcnt(15)
s_nop 0
v_and_b32_dpp v8, v93, v4 row_newbcast:0 row_mask:0xf bank_mask:0xf
v_and_b32_dpp v9, v93, v5 row_newbcast:0 row_mask:0xf bank_mask:0xf
v_and_b32_dpp v10, v93, v6 row_newbcast:0 row_mask:0xf bank_mask:0xf
v_and_b32_dpp v11, v93, v7 row_newbcast:0 row_mask:0xf bank_mask:0xf
s_nop 1
v_mfma_f32_16x16x32_bf16 v[16:19], v[8:11], v[128:131], v[16:19]
s_waitcnt vmcnt(14)
s_add_u32 s42, s41, 65536
s_and_b32 s42, s42, 0xfffff
buffer_load_dwordx4 v[128:131], v2, s[68:71], s42 offen offset:0 nt
v_and_b32_dpp v12, v93, v4 row_newbcast:1 row_mask:0xf bank_mask:0xf
v_and_b32_dpp v13, v93, v5 row_newbcast:1 row_mask:0xf bank_mask:0xf
v_and_b32_dpp v14, v93, v6 row_newbcast:1 row_mask:0xf bank_mask:0xf
v_and_b32_dpp v15, v93, v7 row_newbcast:1 row_mask:0xf bank_mask:0xf
s_nop 1
v_mfma_f32_16x16x32_bf16 v[16:19], v[12:15], v[132:135], v[16:19]
s_waitcnt vmcnt(14)
buffer_load_dwordx4 v[132:135], v2, s[68:71], s42 offen offset:1024 nt
v_and_b32_dpp v8, v93, v4 row_newbcast:2 row_mask:0xf bank_mask:0xf
v_and_b32_dpp v9, v93, v5 row_newbcast:2 row_mask:0xf bank_mask:0xf
v_and_b32_dpp v10, v93, v6 row_newbcast:2 row_mask:0xf bank_mask:0xf
v_and_b32_dpp v11, v93, v7 row_newbcast:2 row_mask:0xf bank_mask:0xf
s_nop 1
v_mfma_f32_16x16x32_bf16 v[16:19], v[8:11], v[136:139], v[16:19]
s_waitcnt vmcnt(14)
buffer_load_dwordx4 v[136:139], v2, s[68:71], s42 offen offset:2048 nt
v_and_b32_dpp v12, v93, v4 row_newbcast:3 row_mask:0xf bank_mask:0xf
v_and_b32_dpp v13, v93, v5 row_newbcast:3 row_mask:0xf bank_mask:0xf
v_and_b32_dpp v14, v93, v6 row_newbcast:3 row_mask:0xf bank_mask:0xf
v_and_b32_dpp v15, v93, v7 row_newbcast:3 row_mask:0xf bank_mask:0xf
s_nop 1
v_mfma_f32_16x16x32_bf16 v[16:19], v[12:15], v[140:143], v[16:19]
s_waitcnt vmcnt(14)
buffer_load_dwordx4 v[140:143], v2, s[68:71], s42 offen offset:3072 nt
v_and_b32_dpp v8, v93, v4 row_newbcast:4 row_mask:0xf bank_mask:0xf
v_and_b32_dpp v9, v93, v5 row_newbcast:4 row_mask:0xf bank_mask:0xf
v_and_b32_dpp v10, v93, v6 row_newbcast:4 row_mask:0xf bank_mask:0xf
v_and_b32_dpp v11, v93, v7 row_newbcast:4 row_mask:0xf bank_mask:0xf
s_nop 1
v_mfma_f32_16x16x32_bf16 v[16:19], v[8:11], v[144:147], v[16:19]
s_waitcnt vmcnt(14)
s_add_u32 s42, s41, 81920
s_and_b32 s42, s42, 0xfffff
buffer_load_dwordx4 v[144:147], v2, s[68:71], s42 offen offset:0 nt
v_and_b32_dpp v12, v93, v4 row_newbcast:5 row_mask:0xf bank_mask:0xf
v_and_b32_dpp v13, v93, v5 row_newbcast:5 row_mask:0xf bank_mask:0xf
v_and_b32_dpp v14, v93, v6 row_newbcast:5 row_mask:0xf bank_mask:0xf
v_and_b32_dpp v15, v93, v7 row_newbcast:5 row_mask:0xf bank_mask:0xf
s_nop 1
v_mfma_f32_16x16x32_bf16 v[16:19], v[12:15], v[148:151], v[16:19]
s_waitcnt vmcnt(14)
buffer_load_dwordx4 v[148:151], v2, s[68:71], s42 offen offset:1024 nt
v_and_b32_dpp v8, v93, v4 row_newbcast:6 row_mask:0xf bank_mask:0xf
v_and_b32_dpp v9, v93, v5 row_newbcast:6 row_mask:0xf bank_mask:0xf
v_and_b32_dpp v10, v93, v6 row_newbcast:6 row_mask:0xf bank_mask:0xf
v_and_b32_dpp v11, v93, v7 row_newbcast:6 row_mask:0xf bank_mask:0xf
s_nop 1
v_mfma_f32_16x16x32_bf16 v[16:19], v[8:11], v[152:155], v[16:19]
s_waitcnt vmcnt(14)
v_and_b32_dpp v12, v93, v4 row_newbcast:7 row_mask:0xf bank_mask:0xf
v_and_b32_dpp v13, v93, v5 row_newbcast:7 row_mask:0xf bank_mask:0xf
v_and_b32_dpp v14, v93, v6 row_newbcast:7 row_mask:0xf bank_mask:0xf
v_and_b32_dpp v15, v93, v7 row_newbcast:7 row_mask:0xf bank_mask:0xf
s_nop 1
v_mfma_f32_16x16x32_bf16 v[16:19], v[12:15], v[156:159], v[16:19]
s_waitcnt vmcnt(13)
v_and_b32_dpp v8, v93, v4 row_newbcast:8 row_mask:0xf bank_mask:0xf
v_and_b32_dpp v9, v93, v5 row_newbcast:8 row_mask:0xf bank_mask:0xf
v_and_b32_dpp v10, v93, v6 row_newbcast:8 row_mask:0xf bank_mask:0xf
v_and_b32_dpp v11, v93, v7 row_newbcast:8 row_mask:0xf bank_mask:0xf
s_nop 1
v_mfma_f32_16x16x32_bf16 v[16:19], v[8:11], v[160:163], v[16:19]
s_waitcnt vmcnt(12)
v_and_b32_dpp v12, v93, v4 row_newbcast:9 row_mask:0xf bank_mask:0xf
v_and_b32_dpp v13, v93, v5 row_newbcast:9 row_mask:0xf bank_mask:0xf
v_and_b32_dpp v14, v93, v6 row_newbcast:9 row_mask:0xf bank_mask:0xf
v_and_b32_dpp v15, v93, v7 row_newbcast:9 row_mask:0xf bank_mask:0xf
s_nop 1
v_mfma_f32_16x16x32_bf16 v[16:19], v[12:15], v[164:167], v[16:19]
s_waitcnt vmcnt(11)
v_and_b32_dpp v8, v93, v4 row_newbcast:10 row_mask:0xf bank_mask:0xf
v_and_b32_dpp v9, v93, v5 row_newbcast:10 row_mask:0xf bank_mask:0xf
v_and_b32_dpp v10, v93, v6 row_newbcast:10 row_mask:0xf bank_mask:0xf
v_and_b32_dpp v11, v93, v7 row_newbcast:10 row_mask:0xf bank_mask:0xf
s_nop 1
v_mfma_f32_16x16x32_bf16 v[16:19], v[8:11], v[168:171], v[16:19]
s_waitcnt vmcnt(10)
v_and_b32_dpp v12, v93, v4 row_newbcast:11 row_mask:0xf bank_mask:0xf
v_and_b32_dpp v13, v93, v5 row_newbcast:11 row_mask:0xf bank_mask:0xf
v_and_b32_dpp v14, v93, v6 row_newbcast:11 row_mask:0xf bank_mask:0xf
v_and_b32_dpp v15, v93, v7 row_newbcast:11 row_mask:0xf bank_mask:0xf
s_nop 1
v_mfma_f32_16x16x32_bf16 v[16:19], v[12:15], v[172:175], v[16:19]
s_waitcnt vmcnt(9)
v_and_b32_dpp v8, v93, v4 row_newbcast:12 row_mask:0xf bank_mask:0xf
v_and_b32_dpp v9, v93, v5 row_newbcast:12 row_mask:0xf bank_mask:0xf
v_and_b32_dpp v10, v93, v6 row_newbcast:12 row_mask:0xf bank_mask:0xf
v_and_b32_dpp v11, v93, v7 row_newbcast:12 row_mask:0xf bank_mask:0xf
s_nop 1
v_mfma_f32_16x16x32_bf16 v[16:19], v[8:11], v[176:179], v[16:19]
s_waitcnt vmcnt(8)
v_and_b32_dpp v12, v93, v4 row_newbcast:13 row_mask:0xf bank_mask:0xf
v_and_b32_dpp v13, v93, v5 row_newbcast:13 row_mask:0xf bank_mask:0xf
v_and_b32_dpp v14, v93, v6 row_newbcast:13 row_mask:0xf bank_mask:0xf
v_and_b32_dpp v15, v93, v7 row_newbcast:13 row_mask:0xf bank_mask:0xf
s_nop 1
v_mfma_f32_16x16x32_bf16 v[16:19], v[12:15], v[180:183], v[16:19]
s_waitcnt vmcnt(7)
v_and_b32_dpp v8, v93, v4 row_newbcast:14 row_mask:0xf bank_mask:0xf
v_and_b32_dpp v9, v93, v5 row_newbcast:14 row_mask:0xf bank_mask:0xf
v_and_b32_dpp v10, v93, v6 row_newbcast:14 row_mask:0xf bank_mask:0xf
v_and_b32_dpp v11, v93, v7 row_newbcast:14 row_mask:0xf bank_mask:0xf
s_nop 1
v_mfma_f32_16x16x32_bf16 v[16:19], v[8:11], v[184:187], v[16:19]
s_waitcnt vmcnt(6)
v_and_b32_dpp v12, v93, v4 row_newbcast:15 row_mask:0xf bank_mask:0xf
v_and_b32_dpp v13, v93, v5 row_newbcast:15 row_mask:0xf bank_mask:0xf
v_and_b32_dpp v14, v93, v6 row_newbcast:15 row_mask:0xf bank_mask:0xf
v_and_b32_dpp v15, v93, v7 row_newbcast:15 row_mask:0xf bank_mask:0xf
s_nop 1
v_mfma_f32_16x16x32_bf16 v[16:19], v[12:15], v[188:191], v[16:19]
s_add_u32 s41, s41, 65536
s_mov_b32 s43, 11
L_vloop:
s_waitcnt lgkmcnt(0)
v_sub_f32 v91, v92, v46
v_mul_f32 v91, 0x3fb8aa3b, v91
v_exp_f32 v91, v91
v_add_u32 v86, 256, v86
ds_read_b32 v92, v86 offset:24064
v_mul_f32 v91, v91, v47
v_cvt_pk_bf16_f32 v93, v91, v91
s_waitcnt vmcnt(5)
s_nop 0
v_and_b32_dpp v8, v93, v4 row_newbcast:0 row_mask:0xf bank_mask:0xf
v_and_b32_dpp v9, v93, v5 row_newbcast:0 row_mask:0xf bank_mask:0xf
v_and_b32_dpp v10, v93, v6 row_newbcast:0 row_mask:0xf bank_mask:0xf
v_and_b32_dpp v11, v93, v7 row_newbcast:0 row_mask:0xf bank_mask:0xf
s_nop 1
v_mfma_f32_16x16x32_bf16 v[16:19], v[8:11], v[128:131], v[16:19]
s_waitcnt vmcnt(4)
s_add_u32 s42, s41, 16384
s_and_b32 s42, s42, 0xfffff
buffer_load_dwordx4 v[152:155], v2, s[68:71], s42 offen offset:2048 nt
v_and_b32_dpp v12, v93, v4 row_newbcast:1 row_mask:0xf bank_mask:0xf
v_and_b32_dpp v13, v93, v5 row_newbcast:1 row_mask:0xf bank_mask:0xf
v_and_b32_dpp v14, v93, v6 row_newbcast:1 row_mask:0xf bank_mask:0xf
v_and_b32_dpp v15, v93, v7 row_newbcast:1 row_mask:0xf bank_mask:0xf
s_nop 1
v_mfma_f32_16x16x32_bf16 v[16:19], v[12:15], v[132:135], v[16:19]
s_waitcnt vmcnt(4)
buffer_load_dwordx4 v[156:159], v2, s[68:71], s42 offen offset:3072 nt
s_add_u32 s42, s41, 32768
s_and_b32 s42, s42, 0xfffff
buffer_load_dwordx4 v[160:163], v2, s[68:71], s42 offen offset:0 nt
v_and_b32_dpp v8, v93, v4 row_newbcast:2 row_mask:0xf bank_mask:0xf
v_and_b32_dpp v9, v93, v5 row_newbcast:2 row_mask:0xf bank_mask:0xf
v_and_b32_dpp v10, v93, v6 row_newbcast:2 row_mask:0xf bank_mask:0xf
v_and_b32_dpp v11, v93, v7 row_newbcast:2 row_mask:0xf bank_mask:0xf
s_nop 1
v_mfma_f32_16x16x32_bf16 v[16:19], v[8:11], v[136:139], v[16:19]
s_waitcnt vmcnt(5)
buffer_load_dwordx4 v[164:167], v2, s[68:71], s42 offen offset:1024 nt
v_and_b32_dpp v12, v93, v4 row_newbcast:3 row_mask:0xf bank_mask:0xf
v_and_b32_dpp v13, v93, v5 row_newbcast:3 row_mask:0xf bank_mask:0xf
v_and_b32_dpp v14, v93, v6 row_newbcast:3 row_mask:0xf bank_mask:0xf
v_and_b32_dpp v15, v93, v7 row_newbcast:3 row_mask:0xf bank_mask:0xf
s_nop 1
v_mfma_f32_16x16x32_bf16 v[16:19], v[12:15], v[140:143], v[16:19]
s_waitcnt vmcnt(5)
v_and_b32_dpp v8, v93, v4 row_newbcast:4 row_mask:0xf bank_mask:0xf
v_and_b32_dpp v9, v93, v5 row_newbcast:4 row_mask:0xf bank_mask:0xf
v_and_b32_dpp v10, v93, v6 row_newbcast:4 row_mask:0xf bank_mask:0xf
v_and_b32_dpp v11, v93, v7 row_newbcast:4 row_mask:0xf bank_mask:0xf
s_nop 1
v_mfma_f32_16x16x32_bf16 v[16:19], v[8:11], v[144:147], v[16:19]
s_waitcnt vmcnt(4)
buffer_load_dwordx4 v[168:171], v2, s[68:71], s42 offen offset:2048 nt
v_and_b32_dpp v12, v93, v4 row_newbcast:5 row_mask:0xf bank_mask:0xf
v_and_b32_dpp v13, v93, v5 row_newbcast:5 row_mask:0xf bank_mask:0xf
v_and_b32_dpp v14, v93, v6 row_newbcast:5 row_mask:0xf bank_mask:0xf
v_and_b32_dpp v15, v93, v7 row_newbcast:5 row_mask:0xf bank_mask:0xf
s_nop 1
v_mfma_f32_16x16x32_bf16 v[16:19], v[12:15], v[148:151], v[16:19]
s_waitcnt vmcnt(4)
buffer_load_dwordx4 v[172:175], v2, s[68:71], s42 offen offset:3072 nt
s_add_u32 s42, s41, 49152
s_and_b32 s42, s42, 0xfffff
buffer_load_dwordx4 v[176:179], v2, s[68:71], s42 offen offset:0 nt
v_and_b32_dpp v8, v93, v4 row_newbcast:6 row_mask:0xf bank_mask:0xf
v_and_b32_dpp v9, v93, v5 row_newbcast:6 row_mask:0xf bank_mask:0xf
v_and_b32_dpp v10, v93, v6 row_newbcast:6 row_mask:0xf bank_mask:0xf
v_and_b32_dpp v11, v93, v7 row_newbcast:6 row_mask:0xf bank_mask:0xf
s_nop 1
v_mfma_f32_16x16x32_bf16 v[16:19], v[8:11], v[152:155], v[16:19]
s_waitcnt vmcnt(5)
buffer_load_dwordx4 v[180:183], v2, s[68:71], s42 offen offset:1024 nt
v_and_b32_dpp v12, v93, v4 row_newbcast:7 row_mask:0xf bank_mask:0xf
v_and_b32_dpp v13, v93, v5 row_newbcast:7 row_mask:0xf bank_mask:0xf
v_and_b32_dpp v14, v93, v6 row_newbcast:7 row_mask:0xf bank_mask:0xf
v_and_b32_dpp v15, v93, v7 row_newbcast:7 row_mask:0xf bank_mask:0xf
s_nop 1
v_mfma_f32_16x16x32_bf16 v[16:19], v[12:15], v[156:159], v[16:19]
s_waitcnt vmcnt(5)
v_and_b32_dpp v8, v93, v4 row_newbcast:8 row_mask:0xf bank_mask:0xf
v_and_b32_dpp v9, v93, v5 row_newbcast:8 row_mask:0xf bank_mask:0xf
v_and_b32_dpp v10, v93, v6 row_newbcast:8 row_mask:0xf bank_mask:0xf
v_and_b32_dpp v11, v93, v7 row_newbcast:8 row_mask:0xf bank_mask:0xf
s_nop 1
v_mfma_f32_16x16x32_bf16 v[16:19], v[8:11], v[160:163], v[16:19]
s_waitcnt vmcnt(4)
buffer_load_dwordx4 v[184:187], v2, s[68:71], s42 offen offset:2048 nt
v_and_b32_dpp v12, v93, v4 row_newbcast:9 row_mask:0xf bank_mask:0xf
v_and_b32_dpp v13, v93, v5 row_newbcast:9 row_mask:0xf bank_mask:0xf
v_and_b32_dpp v14, v93, v6 row_newbcast:9 row_mask:0xf bank_mask:0xf
v_and_b32_dpp v15, v93, v7 row_newbcast:9 row_mask:0xf bank_mask:0xf
s_nop 1
v_mfma_f32_16x16x32_bf16 v[16:19], v[12:15], v[164:167], v[16:19]
s_waitcnt vmcnt(4)
buffer_load_dwordx4 v[188:191], v2, s[68:71], s42 offen offset:3072 nt
s_add_u32 s42, s41, 65536
s_and_b32 s42, s42, 0xfffff
buffer_load_dwordx4 v[128:131], v2, s[68:71], s42 offen offset:0 nt
v_and_b32_dpp v8, v93, v4 row_newbcast:10 row_mask:0xf bank_mask:0xf
v_and_b32_dpp v9, v93, v5 row_newbcast:10 row_mask:0xf bank_mask:0xf
v_and_b32_dpp v10, v93, v6 row_newbcast:10 row_mask:0xf bank_mask:0xf
v_and_b32_dpp v11, v93, v7 row_newbcast:10 row_mask:0xf bank_mask:0xf
s_nop 1
v_mfma_f32_16x16x32_bf16 v[16:19], v[8:11], v[168:171], v[16:19]
s_waitcnt vmcnt(5)
buffer_load_dwordx4 v[132:135], v2, s[68:71], s42 offen offset:1024 nt
v_and_b32_dpp v12, v93, v4 row_newbcast:11 row_mask:0xf bank_mask:0xf
v_and_b32_dpp v13, v93, v5 row_newbcast:11 row_mask:0xf bank_mask:0xf
v_and_b32_dpp v14, v93, v6 row_newbcast:11 row_mask:0xf bank_mask:0xf
v_and_b32_dpp v15, v93, v7 row_newbcast:11 row_mask:0xf bank_mask:0xf
s_nop 1
v_mfma_f32_16x16x32_bf16 v[16:19], v[12:15], v[172:175], v[16:19]
s_waitcnt vmcnt(5)
v_and_b32_dpp v8, v93, v4 row_newbcast:12 row_mask:0xf bank_mask:0xf
v_and_b32_dpp v9, v93, v5 row_newbcast:12 row_mask:0xf bank_mask:0xf
v_and_b32_dpp v10, v93, v6 row_newbcast:12 row_mask:0xf bank_mask:0xf
v_and_b32_dpp v11, v93, v7 row_newbcast:12 row_mask:0xf bank_mask:0xf
s_nop 1
v_mfma_f32_16x16x32_bf16 v[16:19], v[8:11], v[176:179], v[16:19]
s_waitcnt vmcnt(4)
buffer_load_dwordx4 v[136:139], v2, s[68:71], s42 offen offset:2048 nt
v_and_b32_dpp v12, v93, v4 row_newbcast:13 row_mask:0xf bank_mask:0xf
v_and_b32_dpp v13, v93, v5 row_newbcast:13 row_mask:0xf bank_mask:0xf
v_and_b32_dpp v14, v93, v6 row_newbcast:13 row_mask:0xf bank_mask:0xf
v_and_b32_dpp v15, v93, v7 row_newbcast:13 row_mask:0xf bank_mask:0xf
s_nop 1
v_mfma_f32_16x16x32_bf16 v[16:19], v[12:15], v[180:183], v[16:19]
s_waitcnt vmcnt(4)
buffer_load_dwordx4 v[140:143], v2, s[68:71], s42 offen offset:3072 nt
s_add_u32 s42, s41, 81920
s_and_b32 s42, s42, 0xfffff
buffer_load_dwordx4 v[144:147], v2, s[68:71], s42 offen offset:0 nt
v_and_b32_dpp v8, v93, v4 row_newbcast:14 row_mask:0xf bank_mask:0xf
v_and_b32_dpp v9, v93, v5 row_newbcast:14 row_mask:0xf bank_mask:0xf
v_and_b32_dpp v10, v93, v6 row_newbcast:14 row_mask:0xf bank_mask:0xf
v_and_b32_dpp v11, v93, v7 row_newbcast:14 row_mask:0xf bank_mask:0xf
s_nop 1
v_mfma_f32_16x16x32_bf16 v[16:19], v[8:11], v[184:187], v[16:19]
s_waitcnt vmcnt(5)
buffer_load_dwordx4 v[148:151], v2, s[68:71], s42 offen offset:1024 nt
v_and_b32_dpp v12, v93, v4 row_newbcast:15 row_mask:0xf bank_mask:0xf
v_and_b32_dpp v13, v93, v5 row_newbcast:15 row_mask:0xf bank_mask:0xf
v_and_b32_dpp v14, v93, v6 row_newbcast:15 row_mask:0xf bank_mask:0xf
v_and_b32_dpp v15, v93, v7 row_newbcast:15 row_mask:0xf bank_mask:0xf
s_nop 1
v_mfma_f32_16x16x32_bf16 v[16:19], v[12:15], v[188:191], v[16:19]
s_add_u32 s41, s41, 65536
s_sub_u32 s43, s43, 1
s_cmp_lg_u32 s43, 0
s_cbranch_scc1 L_vloop
L_vloop_end:
s_waitcnt lgkmcnt(0)
v_sub_f32 v91, v92, v46
v_mul_f32 v91, 0x3fb8aa3b, v91
v_exp_f32 v91, v91
v_add_u32 v86, 256, v86
ds_read_b32 v92, v86 offset:24064
v_mul_f32 v91, v91, v47
v_cvt_pk_bf16_f32 v93, v91, v91
s_waitcnt vmcnt(5)
s_add_u32 s42, s41, 16384
s_and_b32 s42, s42, 0xfffff
buffer_load_dwordx4 v[152:155], v2, s[68:71], s42 offen offset:2048 nt
buffer_load_dwordx4 v[156:159], v2, s[68:71], s42 offen offset:3072 nt
s_add_u32 s42, s41, 32768
s_and_b32 s42, s42, 0xfffff
buffer_load_dwordx4 v[160:163], v2, s[68:71], s42 offen offset:0 nt
buffer_load_dwordx4 v[164:167], v2, s[68:71], s42 offen offset:1024 nt
buffer_load_dwordx4 v[168:171], v2, s[68:71], s42 offen offset:2048 nt
v_and_b32_dpp v8, v93, v4 row_newbcast:0 row_mask:0xf bank_mask:0xf
v_and_b32_dpp v9, v93, v5 row_newbcast:0 row_mask:0xf bank_mask:0xf
v_and_b32_dpp v10, v93, v6 row_newbcast:0 row_mask:0xf bank_mask:0xf
v_and_b32_dpp v11, v93, v7 row_newbcast:0 row_mask:0xf bank_mask:0xf
s_nop 1
v_mfma_f32_16x16x32_bf16 v[16:19], v[8:11], v[128:131], v[16:19]
s_waitcnt vmcnt(9)
buffer_load_dwordx4 v[172:175], v2, s[68:71], s42 offen offset:3072 nt
v_and_b32_dpp v12, v93, v4 row_newbcast:1 row_mask:0xf bank_mask:0xf
v_and_b32_dpp v13, v93, v5 row_newbcast:1 row_mask:0xf bank_mask:0xf
v_and_b32_dpp v14, v93, v6 row_newbcast:1 row_mask:0xf bank_mask:0xf
v_and_b32_dpp v15, v93, v7 row_newbcast:1 row_mask:0xf bank_mask:0xf
s_nop 1
v_mfma_f32_16x16x32_bf16 v[16:19], v[12:15], v[132:135], v[16:19]
s_waitcnt vmcnt(9)
s_add_u32 s42, s41, 49152
s_and_b32 s42, s42, 0xfffff
buffer_load_dwordx4 v[176:179], v2, s[68:71], s42 offen offset:0 nt
v_and_b32_dpp v8, v93, v4 row_newbcast:2 row_mask:0xf bank_mask:0xf
v_and_b32_dpp v9, v93, v5 row_newbcast:2 row_mask:0xf bank_mask:0xf
v_and_b32_dpp v10, v93, v6 row_newbcast:2 row_mask:0xf bank_mask:0xf
v_and_b32_dpp v11, v93, v7 row_newbcast:2 row_mask:0xf bank_mask:0xf
s_nop 1
v_mfma_f32_16x16x32_bf16 v[16:19], v[8:11], v[136:139], v[16:19]
s_waitcnt vmcnt(9)
buffer_load_dwordx4 v[180:183], v2, s[68:71], s42 offen offset:1024 nt
v_and_b32_dpp v12, v93, v4 row_newbcast:3 row_mask:0xf bank_mask:0xf
v_and_b32_dpp v13, v93, v5 row_newbcast:3 row_mask:0xf bank_mask:0xf
v_and_b32_dpp v14, v93, v6 row_newbcast:3 row_mask:0xf bank_mask:0xf
v_and_b32_dpp v15, v93, v7 row_newbcast:3 row_mask:0xf bank_mask:0xf
s_nop 1
v_mfma_f32_16x16x32_bf16 v[16:19], v[12:15], v[140:143], v[16:19]
s_waitcnt vmcnt(9)
buffer_load_dwordx4 v[184:187], v2, s[68:71], s42 offen offset:2048 nt
v_and_b32_dpp v8, v93, v4 row_newbcast:4 row_mask:0xf bank_mask:0xf
v_and_b32_dpp v9, v93, v5 row_newbcast:4 row_mask:0xf bank_mask:0xf
v_and_b32_dpp v10, v93, v6 row_newbcast:4 row_mask:0xf bank_mask:0xf
v_and_b32_dpp v11, v93, v7 row_newbcast:4 row_mask:0xf bank_mask:0xf
s_nop 1
v_mfma_f32_16x16x32_bf16 v[16:19], v[8:11], v[144:147], v[16:19]
s_waitcnt vmcnt(9)
buffer_load_dwordx4 v[188:191], v2, s[68:71], s42 offen offset:3072 nt
v_and_b32_dpp v12, v93, v4 row_newbcast:5 row_mask:0xf bank_mask:0xf
v_and_b32_dpp v13, v93, v5 row_newbcast:5 row_mask:0xf bank_mask:0xf
v_and_b32_dpp v14, v93, v6 row_newbcast:5 row_mask:0xf bank_mask:0xf
v_and_b32_dpp v15, v93, v7 row_newbcast:5 row_mask:0xf bank_mask:0xf
s_nop 1
v_mfma_f32_16x16x32_bf16 v[16:19], v[12:15], v[148:151], v[16:19]
s_waitcnt vmcnt(9)
s_add_u32 s42, s41, 65536
s_and_b32 s42, s42, 0xfffff
buffer_load_dwordx4 v[128:131], v2, s[68:71], s42 offen offset:0 nt
v_and_b32_dpp v8, v93, v4 row_newbcast:6 row_mask:0xf bank_mask:0xf
v_and_b32_dpp v9, v93, v5 row_newbcast:6 row_mask:0xf bank_mask:0xf
v_and_b32_dpp v10, v93, v6 row_newbcast:6 row_mask:0xf bank_mask:0xf
v_and_b32_dpp v11, v93, v7 row_newbcast:6 row_mask:0xf bank_mask:0xf
s_nop 1
v_mfma_f32_16x16x32_bf16 v[16:19], v[8:11], v[152:155], v[16:19]
s_waitcnt vmcnt(9)
buffer_load_dwordx4 v[132:135], v2, s[68:71], s42 offen offset:1024 nt
v_and_b32_dpp v12, v93, v4 row_newbcast:7 row_mask:0xf bank_mask:0xf
v_and_b32_dpp v13, v93, v5 row_newbcast:7 row_mask:0xf bank_mask:0xf
v_and_b32_dpp v14, v93, v6 row_newbcast:7 row_mask:0xf bank_mask:0xf
v_and_b32_dpp v15, v93, v7 row_newbcast:7 row_mask:0xf bank_mask:0xf
s_nop 1
v_mfma_f32_16x16x32_bf16 v[16:19], v[12:15], v[156:159], v[16:19]
s_waitcnt vmcnt(9)
buffer_load_dwordx4 v[136:139], v2, s[68:71], s42 offen offset:2048 nt
v_and_b32_dpp v8, v93, v4 row_newbcast:8 row_mask:0xf bank_mask:0xf
v_and_b32_dpp v9, v93, v5 row_newbcast:8 row_mask:0xf bank_mask:0xf
v_and_b32_dpp v10, v93, v6 row_newbcast:8 row_mask:0xf bank_mask:0xf
v_and_b32_dpp v11, v93, v7 row_newbcast:8 row_mask:0xf bank_mask:0xf
s_nop 1
v_mfma_f32_16x16x32_bf16 v[16:19], v[8:11], v[160:163], v[16:19]
s_waitcnt vmcnt(9)
buffer_load_dwordx4 v[140:143], v2, s[68:71], s42 offen offset:3072 nt
v_and_b32_dpp v12, v93, v4 row_newbcast:9 row_mask:0xf bank_mask:0xf
v_and_b32_dpp v13, v93, v5 row_newbcast:9 row_mask:0xf bank_mask:0xf
v_and_b32_dpp v14, v93, v6 row_newbcast:9 row_mask:0xf bank_mask:0xf
v_and_b32_dpp v15, v93, v7 row_newbcast:9 row_mask:0xf bank_mask:0xf
s_nop 1
v_mfma_f32_16x16x32_bf16 v[16:19], v[12:15], v[164:167], v[16:19]
s_waitcnt vmcnt(9)
s_add_u32 s42, s41, 81920
s_and_b32 s42, s42, 0xfffff
buffer_load_dwordx4 v[144:147], v2, s[68:71], s42 offen offset:0 nt
v_and_b32_dpp v8, v93, v4 row_newbcast:10 row_mask:0xf bank_mask:0xf
v_and_b32_dpp v9, v93, v5 row_newbcast:10 row_mask:0xf bank_mask:0xf
v_and_b32_dpp v10, v93, v6 row_newbcast:10 row_mask:0xf bank_mask:0xf
v_and_b32_dpp v11, v93, v7 row_newbcast:10 row_mask:0xf bank_mask:0xf
s_nop 1
v_mfma_f32_16x16x32_bf16 v[16:19], v[8:11], v[168:171], v[16:19]
s_waitcnt vmcnt(9)
buffer_load_dwordx4 v[148:151], v2, s[68:71], s42 offen offset:1024 nt
v_and_b32_dpp v12, v93, v4 row_newbcast:11 row_mask:0xf bank_mask:0xf
v_and_b32_dpp v13, v93, v5 row_newbcast:11 row_mask:0xf bank_mask:0xf
v_and_b32_dpp v14, v93, v6 row_newbcast:11 row_mask:0xf bank_mask:0xf
v_and_b32_dpp v15, v93, v7 row_newbcast:11 row_mask:0xf bank_mask:0xf
s_nop 1
v_mfma_f32_16x16x32_bf16 v[16:19], v[12:15], v[172:175], v[16:19]
s_waitcnt vmcnt(9)
buffer_load_dwordx4 v[152:155], v2, s[68:71], s42 offen offset:2048 nt
v_and_b32_dpp v8, v93, v4 row_newbcast:12 row_mask:0xf bank_mask:0xf
v_and_b32_dpp v9, v93, v5 row_newbcast:12 row_mask:0xf bank_mask:0xf
v_and_b32_dpp v10, v93, v6 row_newbcast:12 row_mask:0xf bank_mask:0xf
v_and_b32_dpp v11, v93, v7 row_newbcast:12 row_mask:0xf bank_mask:0xf
s_nop 1
v_mfma_f32_16x16x32_bf16 v[16:19], v[8:11], v[176:179], v[16:19]
s_waitcnt vmcnt(9)
buffer_load_dwordx4 v[156:159], v2, s[68:71], s42 offen offset:3072 nt
v_and_b32_dpp v12, v93, v4 row_newbcast:13 row_mask:0xf bank_mask:0xf
v_and_b32_dpp v13, v93, v5 row_newbcast:13 row_mask:0xf bank_mask:0xf
v_and_b32_dpp v14, v93, v6 row_newbcast:13 row_mask:0xf bank_mask:0xf
v_and_b32_dpp v15, v93, v7 row_newbcast:13 row_mask:0xf bank_mask:0xf
s_nop 1
v_mfma_f32_16x16x32_bf16 v[16:19], v[12:15], v[180:183], v[16:19]
s_waitcnt vmcnt(9)
s_add_u32 s42, s41, 98304
s_and_b32 s42, s42, 0xfffff
buffer_load_dwordx4 v[160:163], v2, s[68:71], s42 offen offset:0 nt
v_and_b32_dpp v8, v93, v4 row_newbcast:14 row_mask:0xf bank_mask:0xf
v_and_b32_dpp v9, v93, v5 row_newbcast:14 row_mask:0xf bank_mask:0xf
v_and_b32_dpp v10, v93, v6 row_newbcast:14 row_mask:0xf bank_mask:0xf
v_and_b32_dpp v11, v93, v7 row_newbcast:14 row_mask:0xf bank_mask:0xf
s_nop 1
v_mfma_f32_16x16x32_bf16 v[16:19], v[8:11], v[184:187], v[16:19]
s_waitcnt vmcnt(9)
buffer_load_dwordx4 v[164:167], v2, s[68:71], s42 offen offset:1024 nt
v_and_b32_dpp v12, v93, v4 row_newbcast:15 row_mask:0xf bank_mask:0xf
v_and_b32_dpp v13, v93, v5 row_newbcast:15 row_mask:0xf bank_mask:0xf
v_and_b32_dpp v14, v93, v6 row_newbcast:15 row_mask:0xf bank_mask:0xf
v_and_b32_dpp v15, v93, v7 row_newbcast:15 row_mask:0xf bank_mask:0xf
s_nop 1
v_mfma_f32_16x16x32_bf16 v[16:19], v[12:15], v[188:191], v[16:19]
s_add_u32 s41, s41, 65536
s_mov_b32 s43, 2
L_vloop2:
s_waitcnt lgkmcnt(0)
v_sub_f32 v91, v92, v46
v_mul_f32 v91, 0x3fb8aa3b, v91
v_exp_f32 v91, v91
v_add_u32 v86, 256, v86
ds_read_b32 v92, v86 offset:24064
v_mul_f32 v91, v91, v47
v_cvt_pk_bf16_f32 v93, v91, v91
s_waitcnt vmcnt(9)
s_add_u32 s42, s41, 32768
s_and_b32 s42, s42, 0xfffff
buffer_load_dwordx4 v[168:171], v2, s[68:71], s42 offen offset:2048 nt
v_and_b32_dpp v8, v93, v4 row_newbcast:0 row_mask:0xf bank_mask:0xf
v_and_b32_dpp v9, v93, v5 row_newbcast:0 row_mask:0xf bank_mask:0xf
v_and_b32_dpp v10, v93, v6 row_newbcast:0 row_mask:0xf bank_mask:0xf
v_and_b32_dpp v11, v93, v7 row_newbcast:0 row_mask:0xf bank_mask:0xf
s_nop 1
v_mfma_f32_16x16x32_bf16 v[16:19], v[8:11], v[128:131], v[16:19]
s_waitcnt vmcnt(9)
buffer_load_dwordx4 v[172:175], v2, s[68:71], s42 offen offset:3072 nt
v_and_b32_dpp v12, v93, v4 row_newbcast:1 row_mask:0xf bank_mask:0xf
v_and_b32_dpp v13, v93, v5 row_newbcast:1 row_mask:0xf bank_mask:0xf
v_and_b32_dpp v14, v93, v6 row_newbcast:1 row_mask:0xf bank_mask:0xf
v_and_b32_dpp v15, v93, v7 row_newbcast:1 row_mask:0xf bank_mask:0xf
s_nop 1
v_mfma_f32_16x16x32_bf16 v[16:19], v[12:15], v[132:135], v[16:19]
s_waitcnt vmcnt(9)
s_add_u32 s42, s41, 49152
s_and_b32 s42, s42, 0xfffff
buffer_load_dwordx4 v[176:179], v2, s[68:71], s42 offen offset:0 nt
v_and_b32_dpp v8, v93, v4 row_newbcast:2 row_mask:0xf bank_mask:0xf
v_and_b32_dpp v9, v93, v5 row_newbcast:2 row_mask:0xf bank_mask:0xf
v_and_b32_dpp v10, v93, v6 row_newbcast:2 row_mask:0xf bank_mask:0xf
v_and_b32_dpp v11, v93, v7 row_newbcast:2 row_mask:0xf bank_mask:0xf
s_nop 1
v_mfma_f32_16x16x32_bf16 v[16:19], v[8:11], v[136:139], v[16:19]
s_waitcnt vmcnt(9)
buffer_load_dwordx4 v[180:183], v2, s[68:71], s42 offen offset:1024 nt
v_and_b32_dpp v12, v93, v4 row_newbcast:3 row_mask:0xf bank_mask:0xf
v_and_b32_dpp v13, v93, v5 row_newbcast:3 row_mask:0xf bank_mask:0xf
v_and_b32_dpp v14, v93, v6 row_newbcast:3 row_mask:0xf bank_mask:0xf
v_and_b32_dpp v15, v93, v7 row_newbcast:3 row_mask:0xf bank_mask:0xf
s_nop 1
v_mfma_f32_16x16x32_bf16 v[16:19], v[12:15], v[140:143], v[16:19]
s_waitcnt vmcnt(9)
buffer_load_dwordx4 v[184:187], v2, s[68:71], s42 offen offset:2048 nt
v_and_b32_dpp v8, v93, v4 row_newbcast:4 row_mask:0xf bank_mask:0xf
v_and_b32_dpp v9, v93, v5 row_newbcast:4 row_mask:0xf bank_mask:0xf
v_and_b32_dpp v10, v93, v6 row_newbcast:4 row_mask:0xf bank_mask:0xf
v_and_b32_dpp v11, v93, v7 row_newbcast:4 row_mask:0xf bank_mask:0xf
s_nop 1
v_mfma_f32_16x16x32_bf16 v[16:19], v[8:11], v[144:147], v[16:19]
s_waitcnt vmcnt(9)
buffer_load_dwordx4 v[188:191], v2, s[68:71], s42 offen offset:3072 nt
v_and_b32_dpp v12, v93, v4 row_newbcast:5 row_mask:0xf bank_mask:0xf
v_and_b32_dpp v13, v93, v5 row_newbcast:5 row_mask:0xf bank_mask:0xf
v_and_b32_dpp v14, v93, v6 row_newbcast:5 row_mask:0xf bank_mask:0xf
v_and_b32_dpp v15, v93, v7 row_newbcast:5 row_mask:0xf bank_mask:0xf
s_nop 1
v_mfma_f32_16x16x32_bf16 v[16:19], v[12:15], v[148:151], v[16:19]
s_waitcnt vmcnt(9)
s_add_u32 s42, s41, 65536
s_and_b32 s42, s42, 0xfffff
buffer_load_dwordx4 v[128:131], v2, s[68:71], s42 offen offset:0 nt
v_and_b32_dpp v8, v93, v4 row_newbcast:6 row_mask:0xf bank_mask:0xf
v_and_b32_dpp v9, v93, v5 row_newbcast:6 row_mask:0xf bank_mask:0xf
v_and_b32_dpp v10, v93, v6 row_newbcast:6 row_mask:0xf bank_mask:0xf
v_and_b32_dpp v11, v93, v7 row_newbcast:6 row_mask:0xf bank_mask:0xf
s_nop 1
v_mfma_f32_16x16x32_bf16 v[16:19], v[8:11], v[152:155], v[16:19]
s_waitcnt vmcnt(9)
buffer_load_dwordx4 v[132:135], v2, s[68:71], s42 offen offset:1024 nt
v_and_b32_dpp v12, v93, v4 row_newbcast:7 row_mask:0xf bank_mask:0xf
v_and_b32_dpp v13, v93, v5 row_newbcast:7 row_mask:0xf bank_mask:0xf
v_and_b32_dpp v14, v93, v6 row_newbcast:7 row_mask:0xf bank_mask:0xf
v_and_b32_dpp v15, v93, v7 row_newbcast:7 row_mask:0xf bank_mask:0xf
s_nop 1
v_mfma_f32_16x16x32_bf16 v[16:19], v[12:15], v[156:159], v[16:19]
s_waitcnt vmcnt(9)
buffer_load_dwordx4 v[136:139], v2, s[68:71], s42 offen offset:2048 nt
v_and_b32_dpp v8, v93, v4 row_newbcast:8 row_mask:0xf bank_mask:0xf
v_and_b32_dpp v9, v93, v5 row_newbcast:8 row_mask:0xf bank_mask:0xf
v_and_b32_dpp v10, v93, v6 row_newbcast:8 row_mask:0xf bank_mask:0xf
v_and_b32_dpp v11, v93, v7 row_newbcast:8 row_mask:0xf bank_mask:0xf
s_nop 1
v_mfma_f32_16x16x32_bf16 v[16:19], v[8:11], v[160:163], v[16:19]
s_waitcnt vmcnt(9)
buffer_load_dwordx4 v[140:143], v2, s[68:71], s42 offen offset:3072 nt
v_and_b32_dpp v12, v93, v4 row_newbcast:9 row_mask:0xf bank_mask:0xf
v_and_b32_dpp v13, v93, v5 row_newbcast:9 row_mask:0xf bank_mask:0xf
v_and_b32_dpp v14, v93, v6 row_newbcast:9 row_mask:0xf bank_mask:0xf
v_and_b32_dpp v15, v93, v7 row_newbcast:9 row_mask:0xf bank_mask:0xf
s_nop 1
v_mfma_f32_16x16x32_bf16 v[16:19], v[12:15], v[164:167], v[16:19]
s_waitcnt vmcnt(9)
s_add_u32 s42, s41, 81920
s_and_b32 s42, s42, 0xfffff
buffer_load_dwordx4 v[144:147], v2, s[68:71], s42 offen offset:0 nt
v_and_b32_dpp v8, v93, v4 row_newbcast:10 row_mask:0xf bank_mask:0xf
v_and_b32_dpp v9, v93, v5 row_newbcast:10 row_mask:0xf bank_mask:0xf
v_and_b32_dpp v10, v93, v6 row_newbcast:10 row_mask:0xf bank_mask:0xf
v_and_b32_dpp v11, v93, v7 row_newbcast:10 row_mask:0xf bank_mask:0xf
s_nop 1
v_mfma_f32_16x16x32_bf16 v[16:19], v[8:11], v[168:171], v[16:19]
s_waitcnt vmcnt(9)
buffer_load_dwordx4 v[148:151], v2, s[68:71], s42 offen offset:1024 nt
v_and_b32_dpp v12, v93, v4 row_newbcast:11 row_mask:0xf bank_mask:0xf
v_and_b32_dpp v13, v93, v5 row_newbcast:11 row_mask:0xf bank_mask:0xf
v_and_b32_dpp v14, v93, v6 row_newbcast:11 row_mask:0xf bank_mask:0xf
v_and_b32_dpp v15, v93, v7 row_newbcast:11 row_mask:0xf bank_mask:0xf
s_nop 1
v_mfma_f32_16x16x32_bf16 v[16:19], v[12:15], v[172:175], v[16:19]
s_waitcnt vmcnt(9)
buffer_load_dwordx4 v[152:155], v2, s[68:71], s42 offen offset:2048 nt
v_and_b32_dpp v8, v93, v4 row_newbcast:12 row_mask:0xf bank_mask:0xf
v_and_b32_dpp v9, v93, v5 row_newbcast:12 row_mask:0xf bank_mask:0xf
v_and_b32_dpp v10, v93, v6 row_newbcast:12 row_mask:0xf bank_mask:0xf
v_and_b32_dpp v11, v93, v7 row_newbcast:12 row_mask:0xf bank_mask:0xf
s_nop 1
v_mfma_f32_16x16x32_bf16 v[16:19], v[8:11], v[176:179], v[16:19]
s_waitcnt vmcnt(9)
buffer_load_dwordx4 v[156:159], v2, s[68:71], s42 offen offset:3072 nt
v_and_b32_dpp v12, v93, v4 row_newbcast:13 row_mask:0xf bank_mask:0xf
v_and_b32_dpp v13, v93, v5 row_newbcast:13 row_mask:0xf bank_mask:0xf
v_and_b32_dpp v14, v93, v6 row_newbcast:13 row_mask:0xf bank_mask:0xf
v_and_b32_dpp v15, v93, v7 row_newbcast:13 row_mask:0xf bank_mask:0xf
s_nop 1
v_mfma_f32_16x16x32_bf16 v[16:19], v[12:15], v[180:183], v[16:19]
s_waitcnt vmcnt(9)
s_add_u32 s42, s41, 98304
s_and_b32 s42, s42, 0xfffff
buffer_load_dwordx4 v[160:163], v2, s[68:71], s42 offen offset:0 nt
v_and_b32_dpp v8, v93, v4 row_newbcast:14 row_mask:0xf bank_mask:0xf
v_and_b32_dpp v9, v93, v5 row_newbcast:14 row_mask:0xf bank_mask:0xf
v_and_b32_dpp v10, v93, v6 row_newbcast:14 row_mask:0xf bank_mask:0xf
v_and_b32_dpp v11, v93, v7 row_newbcast:14 row_mask:0xf bank_mask:0xf
s_nop 1
v_mfma_f32_16x16x32_bf16 v[16:19], v[8:11], v[184:187], v[16:19]
s_waitcnt vmcnt(9)
buffer_load_dwordx4 v[164:167], v2, s[68:71], s42 offen offset:1024 nt
v_and_b32_dpp v12, v93, v4 row_newbcast:15 row_mask:0xf bank_mask:0xf
v_and_b32_dpp v13, v93, v5 row_newbcast:15 row_mask:0xf bank_mask:0xf
v_and_b32_dpp v14, v93, v6 row_newbcast:15 row_mask:0xf bank_mask:0xf
v_and_b32_dpp v15, v93, v7 row_newbcast:15 row_mask:0xf bank_mask:0xf
s_nop 1
v_mfma_f32_16x16x32_bf16 v[16:19], v[12:15], v[188:191], v[16:19]
s_add_u32 s41, s41, 65536
s_sub_u32 s43, s43, 1
s_cmp_lg_u32 s43, 0
s_cbranch_scc1 L_vloop2
v_lshrrev_b32 v48, 1, v60
v_lshlrev_b32 v48, 9, v48
v_and_b32 v49, 1, v60
v_lshl_add_u32 v48, v49, 4, v48
v_lshl_add_u32 v48, v61, 5, v48
v_lshrrev_b32 v49, 2, v48
s_cmp_lg_u32 s3, 2
s_cbranch_scc1 L_noyf
v_mov_b32 v3, 11060
s_mov_b32 s51, 1600000
Lw_5:
ds_read_b32 v127, v3
s_waitcnt lgkmcnt(0)
v_readfirstlane_b32 s37, v127
s_nop 0
s_cmp_ge_u32 s37, 1
s_cbranch_scc1 Lw_5_ok
s_sub_u32 s51, s51, 1
s_cmp_lg_u32 s51, 0
s_cbranch_scc1 Lw_5
Lw_5_ok:
v_lshlrev_b32 v50, 2, v1
ds_read_b128 v[28:31], v2 offset:11264
ds_read_b32 v32, v50 offset:12288
L_noyf:
s_waitcnt lgkmcnt(0)
v_sub_f32 v91, v92, v46
v_mul_f32 v91, 0x3fb8aa3b, v91
v_exp_f32 v91, v91
s_nop 0
v_mul_f32 v91, v91, v47
v_cvt_pk_bf16_f32 v93, v91, v91
s_waitcnt vmcnt(9)
s_add_u32 s42, s41, 32768
s_and_b32 s42, s42, 0xfffff
buffer_load_dwordx4 v[168:171], v2, s[68:71], s42 offen offset:2048 nt
v_and_b32_dpp v8, v93, v4 row_newbcast:0 row_mask:0xf bank_mask:0xf
v_and_b32_dpp v9, v93, v5 row_newbcast:0 row_mask:0xf bank_mask:0xf
v_and_b32_dpp v10, v93, v6 row_newbcast:0 row_mask:0xf bank_mask:0xf
v_and_b32_dpp v11, v93, v7 row_newbcast:0 row_mask:0xf bank_mask:0xf
s_nop 1
v_mfma_f32_16x16x32_bf16 v[16:19], v[8:11], v[128:131], v[16:19]
s_waitcnt vmcnt(9)
buffer_load_dwordx4 v[172:175], v2, s[68:71], s42 offen offset:3072 nt
v_and_b32_dpp v12, v93, v4 row_newbcast:1 row_mask:0xf bank_mask:0xf
v_and_b32_dpp v13, v93, v5 row_newbcast:1 row_mask:0xf bank_mask:0xf
v_and_b32_dpp v14, v93, v6 row_newbcast:1 row_mask:0xf bank_mask:0xf
v_and_b32_dpp v15, v93, v7 row_newbcast:1 row_mask:0xf bank_mask:0xf
s_nop 1
v_mfma_f32_16x16x32_bf16 v[16:19], v[12:15], v[132:135], v[16:19]
s_waitcnt vmcnt(9)
s_add_u32 s42, s41, 49152
s_and_b32 s42, s42, 0xfffff
buffer_load_dwordx4 v[176:179], v2, s[68:71], s42 offen offset:0 nt
v_and_b32_dpp v8, v93, v4 row_newbcast:2 row_mask:0xf bank_mask:0xf
v_and_b32_dpp v9, v93, v5 row_newbcast:2 row_mask:0xf bank_mask:0xf
v_and_b32_dpp v10, v93, v6 row_newbcast:2 row_mask:0xf bank_mask:0xf
v_and_b32_dpp v11, v93, v7 row_newbcast:2 row_mask:0xf bank_mask:0xf
s_nop 1
v_mfma_f32_16x16x32_bf16 v[16:19], v[8:11], v[136:139], v[16:19]
s_waitcnt vmcnt(9)
buffer_load_dwordx4 v[180:183], v2, s[68:71], s42 offen offset:1024 nt
v_and_b32_dpp v12, v93, v4 row_newbcast:3 row_mask:0xf bank_mask:0xf
v_and_b32_dpp v13, v93, v5 row_newbcast:3 row_mask:0xf bank_mask:0xf
v_and_b32_dpp v14, v93, v6 row_newbcast:3 row_mask:0xf bank_mask:0xf
v_and_b32_dpp v15, v93, v7 row_newbcast:3 row_mask:0xf bank_mask:0xf
s_nop 1
v_mfma_f32_16x16x32_bf16 v[16:19], v[12:15], v[140:143], v[16:19]
s_waitcnt vmcnt(9)
buffer_load_dwordx4 v[184:187], v2, s[68:71], s42 offen offset:2048 nt
v_and_b32_dpp v8, v93, v4 row_newbcast:4 row_mask:0xf bank_mask:0xf
v_and_b32_dpp v9, v93, v5 row_newbcast:4 row_mask:0xf bank_mask:0xf
v_and_b32_dpp v10, v93, v6 row_newbcast:4 row_mask:0xf bank_mask:0xf
v_and_b32_dpp v11, v93, v7 row_newbcast:4 row_mask:0xf bank_mask:0xf
s_nop 1
v_mfma_f32_16x16x32_bf16 v[16:19], v[8:11], v[144:147], v[16:19]
s_waitcnt vmcnt(9)
buffer_load_dwordx4 v[188:191], v2, s[68:71], s42 offen offset:3072 nt
v_and_b32_dpp v12, v93, v4 row_newbcast:5 row_mask:0xf bank_mask:0xf
v_and_b32_dpp v13, v93, v5 row_newbcast:5 row_mask:0xf bank_mask:0xf
v_and_b32_dpp v14, v93, v6 row_newbcast:5 row_mask:0xf bank_mask:0xf
v_and_b32_dpp v15, v93, v7 row_newbcast:5 row_mask:0xf bank_mask:0xf
s_nop 1
v_mfma_f32_16x16x32_bf16 v[16:19], v[12:15], v[148:151], v[16:19]
s_waitcnt vmcnt(9)
v_and_b32_dpp v8, v93, v4 row_newbcast:6 row_mask:0xf bank_mask:0xf
v_and_b32_dpp v9, v93, v5 row_newbcast:6 row_mask:0xf bank_mask:0xf
v_and_b32_dpp v10, v93, v6 row_newbcast:6 row_mask:0xf bank_mask:0xf
v_and_b32_dpp v11, v93, v7 row_newbcast:6 row_mask:0xf bank_mask:0xf
s_nop 1
v_mfma_f32_16x16x32_bf16 v[16:19], v[8:11], v[152:155], v[16:19]
s_waitcnt vmcnt(8)
v_and_b32_dpp v12, v93, v4 row_newbcast:7 row_mask:0xf bank_mask:0xf
v_and_b32_dpp v13, v93, v5 row_newbcast:7 row_mask:0xf bank_mask:0xf
v_and_b32_dpp v14, v93, v6 row_newbcast:7 row_mask:0xf bank_mask:0xf
v_and_b32_dpp v15, v93, v7 row_newbcast:7 row_mask:0xf bank_mask:0xf
s_nop 1
v_mfma_f32_16x16x32_bf16 v[16:19], v[12:15], v[156:159], v[16:19]
s_waitcnt vmcnt(7)
v_and_b32_dpp v8, v93, v4 row_newbcast:8 row_mask:0xf bank_mask:0xf
v_and_b32_dpp v9, v93, v5 row_newbcast:8 row_mask:0xf bank_mask:0xf
v_and_b32_dpp v10, v93, v6 row_newbcast:8 row_mask:0xf bank_mask:0xf
v_and_b32_dpp v11, v93, v7 row_newbcast:8 row_mask:0xf bank_mask:0xf
s_nop 1
v_mfma_f32_16x16x32_bf16 v[16:19], v[8:11], v[160:163], v[16:19]
s_waitcnt vmcnt(6)
v_and_b32_dpp v12, v93, v4 row_newbcast:9 row_mask:0xf bank_mask:0xf
v_and_b32_dpp v13, v93, v5 row_newbcast:9 row_mask:0xf bank_mask:0xf
v_and_b32_dpp v14, v93, v6 row_newbcast:9 row_mask:0xf bank_mask:0xf
v_and_b32_dpp v15, v93, v7 row_newbcast:9 row_mask:0xf bank_mask:0xf
s_nop 1
v_mfma_f32_16x16x32_bf16 v[16:19], v[12:15], v[164:167], v[16:19]
s_waitcnt vmcnt(5)
v_and_b32_dpp v8, v93, v4 row_newbcast:10 row_mask:0xf bank_mask:0xf
v_and_b32_dpp v9, v93, v5 row_newbcast:10 row_mask:0xf bank_mask:0xf
v_and_b32_dpp v10, v93, v6 row_newbcast:10 row_mask:0xf bank_mask:0xf
v_and_b32_dpp v11, v93, v7 row_newbcast:10 row_mask:0xf bank_mask:0xf
s_nop 1
v_mfma_f32_16x16x32_bf16 v[16:19], v[8:11], v[168:171], v[16:19]
s_waitcnt vmcnt(4)
v_and_b32_dpp v12, v93, v4 row_newbcast:11 row_mask:0xf bank_mask:0xf
v_and_b32_dpp v13, v93, v5 row_newbcast:11 row_mask:0xf bank_mask:0xf
v_and_b32_dpp v14, v93, v6 row_newbcast:11 row_mask:0xf bank_mask:0xf
v_and_b32_dpp v15, v93, v7 row_newbcast:11 row_mask:0xf bank_mask:0xf
s_nop 1
v_mfma_f32_16x16x32_bf16 v[16:19], v[12:15], v[172:175], v[16:19]
s_waitcnt vmcnt(3)
v_and_b32_dpp v8, v93, v4 row_newbcast:12 row_mask:0xf bank_mask:0xf
v_and_b32_dpp v9, v93, v5 row_newbcast:12 row_mask:0xf bank_mask:0xf
v_and_b32_dpp v10, v93, v6 row_newbcast:12 row_mask:0xf bank_mask:0xf
v_and_b32_dpp v11, v93, v7 row_newbcast:12 row_mask:0xf bank_mask:0xf
s_nop 1
v_mfma_f32_16x16x32_bf16 v[16:19], v[8:11], v[176:179], v[16:19]
s_waitcnt vmcnt(2)
v_and_b32_dpp v12, v93, v4 row_newbcast:13 row_mask:0xf bank_mask:0xf
v_and_b32_dpp v13, v93, v5 row_newbcast:13 row_mask:0xf bank_mask:0xf
v_and_b32_dpp v14, v93, v6 row_newbcast:13 row_mask:0xf bank_mask:0xf
v_and_b32_dpp v15, v93, v7 row_newbcast:13 row_mask:0xf bank_mask:0xf
s_nop 1
v_mfma_f32_16x16x32_bf16 v[16:19], v[12:15], v[180:183], v[16:19]
s_waitcnt vmcnt(1)
v_and_b32_dpp v8, v93, v4 row_newbcast:14 row_mask:0xf bank_mask:0xf
v_and_b32_dpp v9, v93, v5 row_newbcast:14 row_mask:0xf bank_mask:0xf
v_and_b32_dpp v10, v93, v6 row_newbcast:14 row_mask:0xf bank_mask:0xf
v_and_b32_dpp v11, v93, v7 row_newbcast:14 row_mask:0xf bank_mask:0xf
s_nop 1
v_mfma_f32_16x16x32_bf16 v[16:19], v[8:11], v[184:187], v[16:19]
s_waitcnt vmcnt(0)
v_and_b32_dpp v12, v93, v4 row_newbcast:15 row_mask:0xf bank_mask:0xf
v_and_b32_dpp v13, v93, v5 row_newbcast:15 row_mask:0xf bank_mask:0xf
v_and_b32_dpp v14, v93, v6 row_newbcast:15 row_mask:0xf bank_mask:0xf
v_and_b32_dpp v15, v93, v7 row_newbcast:15 row_mask:0xf bank_mask:0xf
s_nop 1
v_mfma_f32_16x16x32_bf16 v[16:19], v[12:15], v[188:191], v[16:19]
v_lshlrev_b32 v3, 5, v61
v_lshl_add_u32 v3, v60, 4, v3
s_lshl_b32 s37, s45, 11
s_lshl_b32 s38, s3, 9
s_add_u32 s37, s37, s38
s_add_u32 s37, s37, 2097152
s_mov_b32 exec_hi, 0
s_nop 0
buffer_store_dwordx4 v[16:19], v3, s[72:75], s37 offen sc1
s_mov_b64 exec, -1
s_cmp_lg_u32 s3, 2
s_cbranch_scc1 L_noxy
s_lshl_b32 s37, s82, 1
s_add_u32 s37, s37, 1048576
buffer_store_dwordx4 v[28:31], v48, s[72:75], s37 offen sc1
buffer_store_dword v32, v49, s[72:75], s37 offen offset:1024 sc1
L_noxy:
s_barrier
s_cmp_lg_u32 s3, 1
s_cbranch_scc1 L_sexit
s_and_b32 s37, s32, 7
s_cmp_eq_u32 s37, s33
s_cbranch_scc0 L_sexit
s_lshr_b32 s81, s32, 3
v_lshlrev_b32 v88, 10, v60
v_bfe_u32 v86, v1, 3, 1
v_lshl_add_u32 v88, v86, 9, v88
v_and_b32 v89, 7, v1
v_lshl_add_u32 v88, v89, 4, v88
v_lshlrev_b32 v86, 10, v60
v_add_u32 v86, v86, v88
v_lshlrev_b32 v85, 11, v60
v_bfe_u32 v28, v1, 3, 1
v_lshl_add_u32 v85, v28, 7, v85
v_lshl_add_u32 v85, v89, 2, v85
s_lshl_b32 s79, s83, 3
s_mov_b32 s50, 400000
L_gy:
s_lshl_b32 s40, s33, 16
s_add_u32 s40, s40, 1048576
s_lshl_b32 s38, s81, 5
s_add_u32 s39, s40, s38
s_add_u32 s39, s39, 1024
s_lshl_b32 s38, s81, 7
s_add_u32 s40, s40, s38
buffer_load_dwordx4 v[160:163], v86, s[72:75], s40 offen sc1
buffer_load_dword v192, v85, s[72:75], s39 offen sc1
s_add_u32 s40, s40, 8192
s_add_u32 s39, s39, 8192
buffer_load_dwordx4 v[164:167], v86, s[72:75], s40 offen sc1
buffer_load_dword v193, v85, s[72:75], s39 offen sc1
s_add_u32 s40, s40, 8192
s_add_u32 s39, s39, 8192
buffer_load_dwordx4 v[168:171], v86, s[72:75], s40 offen sc1
buffer_load_dword v194, v85, s[72:75], s39 offen sc1
s_add_u32 s40, s40, 8192
s_add_u32 s39, s39, 8192
buffer_load_dwordx4 v[172:175], v86, s[72:75], s40 offen sc1
buffer_load_dword v195, v85, s[72:75], s39 offen sc1
s_add_u32 s40, s40, 8192
s_add_u32 s39, s39, 8192
buffer_load_dwordx4 v[176:179], v86, s[72:75], s40 offen sc1
buffer_load_dword v196, v85, s[72:75], s39 offen sc1
s_add_u32 s40, s40, 8192
s_add_u32 s39, s39, 8192
buffer_load_dwordx4 v[180:183], v86, s[72:75], s40 offen sc1
buffer_load_dword v197, v85, s[72:75], s39 offen sc1
s_add_u32 s40, s40, 8192
s_add_u32 s39, s39, 8192
buffer_load_dwordx4 v[184:187], v86, s[72:75], s40 offen sc1
buffer_load_dword v198, v85, s[72:75], s39 offen sc1
s_add_u32 s40, s40, 8192
s_add_u32 s39, s39, 8192
buffer_load_dwordx4 v[188:191], v86, s[72:75], s40 offen sc1
buffer_load_dword v199, v85, s[72:75], s39 offen sc1
s_waitcnt vmcnt(0)
v_add3_u32 v28, v160, v161, v162
v_add3_u32 v28, v28, v163, v164
v_add3_u32 v28, v28, v165, v166
v_add3_u32 v28, v28, v167, v168
v_add3_u32 v28, v28, v169, v170
v_add3_u32 v28, v28, v171, v172
v_add3_u32 v28, v28, v173, v174
v_add3_u32 v28, v28, v175, v176
v_add3_u32 v28, v28, v177, v178
v_add3_u32 v28, v28, v179, v180
v_add3_u32 v28, v28, v181, v182
v_add3_u32 v28, v28, v183, v184
v_add3_u32 v28, v28, v185, v186
v_add3_u32 v28, v28, v187, v188
v_add3_u32 v28, v28, v189, v190
v_add3_u32 v28, v28, v191, v192
v_add3_u32 v28, v28, v193, v194
v_add3_u32 v28, v28, v195, v196
v_add3_u32 v28, v28, v197, v198
v_add_u32 v28, v28, v199
v_cmp_ne_u32 vcc, s79, v28
s_nop 0
s_cmp_eq_u64 vcc, 0
s_cbranch_scc1 L_gy_ok
s_mov_b64 exec, vcc
s_sleep 8
s_sub_u32 s50, s50, 1
s_cmp_lg_u32 s50, 0
s_cbranch_scc1 L_gy
L_gy_ok:
s_mov_b64 exec, -1
v_add_f32 v28, v160, v164
v_add_f32 v32, v168, v172
v_add_f32 v36, v176, v180
v_add_f32 v40, v184, v188
v_add_f32 v29, v161, v165
v_add_f32 v33, v169, v173
v_add_f32 v37, v177, v181
v_add_f32 v41, v185, v189
v_add_f32 v30, v162, v166
v_add_f32 v34, v170, v174
v_add_f32 v38, v178, v182
v_add_f32 v42, v186, v190
v_add_f32 v31, v163, v167
v_add_f32 v35, v171, v175
v_add_f32 v39, v179, v183
v_add_f32 v43, v187, v191
v_add_f32 v28, v28, v32
v_add_f32 v36, v36, v40
v_add_f32 v29, v29, v33
v_add_f32 v37, v37, v41
v_add_f32 v30, v30, v34
v_add_f32 v38, v38, v42
v_add_f32 v31, v31, v35
v_add_f32 v39, v39, v43
v_add_f32 v28, v28, v36
v_add_f32 v29, v29, v37
v_add_f32 v30, v30, v38
v_add_f32 v31, v31, v39
v_mov_b32 v32, v28
v_mov_b32 v33, v29
v_mov_b32 v34, v30
v_mov_b32 v35, v31
v_permlane16_swap_b32 v28, v32
v_permlane16_swap_b32 v29, v33
v_permlane16_swap_b32 v30, v34
v_permlane16_swap_b32 v31, v35
v_add_f32 v28, v28, v32
v_add_f32 v29, v29, v33
v_add_f32 v30, v30, v34
v_add_f32 v31, v31, v35
v_mov_b32 v32, v28
v_mov_b32 v33, v29
v_mov_b32 v34, v30
v_mov_b32 v35, v31
v_permlane32_swap_b32 v28, v32
v_permlane32_swap_b32 v29, v33
v_permlane32_swap_b32 v30, v34
v_permlane32_swap_b32 v31, v35
v_add_f32 v28, v28, v32
v_add_f32 v29, v29, v33
v_add_f32 v30, v30, v34
v_add_f32 v31, v31, v35
v_cvt_pk_bf16_f32 v28, v28, v28
v_and_b32 v28, 0xffff0000, v28
v_cvt_pk_bf16_f32 v29, v29, v29
v_and_b32 v29, 0xffff0000, v29
v_cvt_pk_bf16_f32 v30, v30, v30
v_and_b32 v30, 0xffff0000, v30
v_cvt_pk_bf16_f32 v31, v31, v31
v_and_b32 v31, 0xffff0000, v31
v_mul_f32 v37, 0xbfb8aa3b, v28
v_exp_f32 v37, v37
s_nop 0
v_add_f32 v37, 1.0, v37
v_rcp_f32 v38, v37
s_nop 0
v_mul_f32 v16, v28, v38
v_cvt_pk_bf16_f32 v16, v16, v16
v_and_b32 v16, 0xffff0000, v16
v_mul_f32 v37, 0xbfb8aa3b, v29
v_exp_f32 v37, v37
s_nop 0
v_add_f32 v37, 1.0, v37
v_rcp_f32 v38, v37
s_nop 0
v_mul_f32 v17, v29, v38
v_cvt_pk_bf16_f32 v17, v17, v17
v_and_b32 v17, 0xffff0000, v17
v_mul_f32 v37, 0xbfb8aa3b, v30
v_exp_f32 v37, v37
s_nop 0
v_add_f32 v37, 1.0, v37
v_rcp_f32 v38, v37
s_nop 0
v_mul_f32 v18, v30, v38
v_cvt_pk_bf16_f32 v18, v18, v18
v_and_b32 v18, 0xffff0000, v18
v_mul_f32 v37, 0xbfb8aa3b, v31
v_exp_f32 v37, v37
s_nop 0
v_add_f32 v37, 1.0, v37
v_rcp_f32 v38, v37
s_nop 0
v_mul_f32 v19, v31, v38
v_cvt_pk_bf16_f32 v19, v19, v19
v_and_b32 v19, 0xffff0000, v19
s_mov_b64 exec, 0xffff
ds_write_b128 v2, v[16:19] offset:19968
s_mov_b64 exec, -1
s_waitcnt lgkmcnt(0)
v_mov_b32 v3, 11052
v_mov_b32 v127, 1
s_mov_b64 exec, 1
ds_add_u32 v3, v127
s_mov_b64 exec, -1
L_sexit:
s_endpgm
L_helper_issue:
s_mov_b32 s72, s30
s_mov_b32 s73, s31
s_mov_b32 s74, 16777216
s_mov_b32 s75, 0x20000
s_mov_b32 s84, s8
s_mov_b32 s85, s9
s_mov_b32 s86, 0
s_mov_b32 s87, 0x20000
s_and_b32 s53, s2, 7
s_lshl_b32 s53, s53, 3
s_lshr_b32 s37, s2, 3
s_and_b32 s38, s37, 7
s_add_u32 s53, s53, s38
s_lshr_b32 s54, s37, 3
v_lshrrev_b32 v81, 3, v61
v_lshl_add_u32 v81, v81, 2, v60
v_mul_u32_u24 v81, 7168, v81
v_and_b32 v82, 7, v61
v_lshl_add_u32 v81, v82, 4, v81
v_mov_b32 v83, 0x40000000
v_cmp_gt_u32 vcc, 7, v82
s_nop 1
v_cndmask_b32 v81, v83, v81, vcc
s_and_b32 s37, s36, 1
s_cmp_eq_u32 s37, 0
s_cselect_b32 s39, s20, s22
s_cselect_b32 s40, s21, s23
s_mul_i32 s37, s53, 112
s_add_u32 s60, s39, s37
s_addc_u32 s61, s40, 0
s_mov_b32 s62, 7332976
s_mov_b32 s63, 0x20000
s_lshl_b32 s37, s54, 8
s_lshr_b32 s38, s36, 1
s_lshl_b32 s38, s38, 7
s_add_u32 s37, s37, s38
s_mul_i32 s41, s37, 7168
v_lshlrev_b32 v82, 11, v60
v_lshl_add_u32 v82, v61, 4, v82
s_cmp_lg_u32 s36, 3
s_cbranch_scc0 L_wd_oob
v_mov_b32 v83, v82
L_wd_oob:
s_mul_i32 s37, s32, 229376
s_lshl_b32 s38, s33, 8
s_add_u32 s37, s37, s38
s_add_u32 s64, s24, s37
s_addc_u32 s65, s25, 0
s_mov_b32 s66, 227584
s_mov_b32 s67, 0x20000
s_lshl_b32 s37, s32, 18
s_add_u32 s37, s37, s38
s_add_u32 s68, s16, s37
s_addc_u32 s69, s17, 0
s_mov_b32 s70, 260352
s_mov_b32 s71, 0x20000
s_lshl_b32 s43, s36, 16
s_waitcnt lgkmcnt(0)
s_barrier
s_add_u32 s83, s83, 1
s_cmp_lg_u32 s36, 0
s_cbranch_scc1 L_noclear
v_mov_b32 v20, -1
v_mov_b32 v21, -1
v_mov_b32 v22, -1
v_mov_b32 v23, -1
s_add_u32 s38, s82, 3145728
buffer_store_dwordx4 v[20:23], v2, s[72:75], s38 offen sc1
s_lshl_b32 s37, s45, 11
s_add_u32 s38, s37, 2097152
buffer_store_dwordx4 v[20:23], v2, s[72:75], s38 offen sc1
buffer_store_dwordx4 v[20:23], v2, s[72:75], s38 offen offset:1024 sc1
s_lshl_b32 s38, s45, 7
s_add_u32 s38, s38, 4194304
s_mov_b64 exec, 0xff
buffer_store_dwordx4 v[20:23], v2, s[72:75], s38 offen sc1
s_mov_b64 exec, -1
L_noclear:
s_add_u32 s42, s41, 0
buffer_load_dwordx4 v[128:131], v81, s[60:63], s42 offen nt
s_add_u32 s42, s41, 57344
buffer_load_dwordx4 v[132:135], v81, s[60:63], s42 offen nt
s_add_u32 s42, s41, 114688
buffer_load_dwordx4 v[136:139], v81, s[60:63], s42 offen nt
s_add_u32 s42, s41, 172032
buffer_load_dwordx4 v[140:143], v81, s[60:63], s42 offen nt
v_and_b32 v62, 1, v61
v_lshlrev_b32 v62, 4, v62
v_mov_b32 v63, 0xffff
v_lshlrev_b32 v63, v62, v63
v_bfe_u32 v64, v61, 1, 2
v_cmp_eq_u32 vcc, 0, v64
s_nop 1
v_cndmask_b32 v4, 0, v63, vcc
v_cmp_eq_u32 vcc, 1, v64
s_nop 1
v_cndmask_b32 v5, 0, v63, vcc
v_cmp_eq_u32 vcc, 2, v64
s_nop 1
v_cndmask_b32 v6, 0, v63, vcc
v_cmp_eq_u32 vcc, 3, v64
s_nop 1
v_cndmask_b32 v7, 0, v63, vcc
v_lshrrev_b32 v62, 3, v61
v_lshl_add_u32 v66, v62, 2, v60
v_mul_u32_u24 v65, 1040, v66
s_cmp_lg_u32 s36, 0
s_cbranch_scc1 L_hstart
s_setprio 2
v_mov_b32 v3, 11044
s_mov_b32 s51, 1600000
Lw_6:
ds_read_b32 v127, v3
s_waitcnt lgkmcnt(0)
v_readfirstlane_b32 s37, v127
s_nop 0
s_cmp_ge_u32 s37, 4
s_cbranch_scc1 Lw_6_ok
s_sub_u32 s51, s51, 1
s_cmp_lg_u32 s51, 0
s_cbranch_scc1 Lw_6
Lw_6_ok:
ds_read_b128 v[28:31], v2 offset:11264
ds_read_b128 v[32:35], v2 offset:12288
ds_read_b128 v[36:39], v2 offset:13312
ds_read_b128 v[40:43], v2 offset:14336
s_waitcnt lgkmcnt(0)
v_add_f32 v16, v28, v32
v_add_f32 v20, v36, v40
v_add_f32 v17, v29, v33
v_add_f32 v21, v37, v41
v_add_f32 v18, v30, v34
v_add_f32 v22, v38, v42
v_add_f32 v19, v31, v35
v_add_f32 v23, v39, v43
v_add_f32 v16, v16, v20
v_add_f32 v17, v17, v21
v_add_f32 v18, v18, v22
v_add_f32 v19, v19, v23
s_waitcnt vmcnt(0)
v_add3_u32 v20, v16, v17, v18
v_add_u32 v20, v20, v19
v_sub_u32 v20, s83, v20
s_lshl_b32 s37, s45, 11
v_lshlrev_b32 v21, 2, v1
buffer_store_dwordx4 v[16:19], v2, s[72:75], s37 offen sc1
buffer_store_dword v20, v21, s[72:75], s37 offen offset:1024 sc1
v_lshrrev_b32 v85, 5, v1
v_lshlrev_b32 v85, 11, v85
v_and_b32 v86, 31, v1
v_lshl_add_u32 v96, v86, 2, v85
v_lshl_add_u32 v85, v86, 4, v85
s_lshl_b32 s40, s32, 14
s_lshl_b32 s38, s34, 7
s_add_u32 s39, s40, s38
s_add_u32 s39, s39, 1024
s_lshl_b32 s38, s34, 9
s_add_u32 s40, s40, s38
s_mov_b32 s50, 400000
v_and_b32 v86, 7, v1
v_lshlrev_b32 v86, 11, v86
s_lshl_b32 s38, s32, 14
s_add_u32 s38, s38, 1008
L_qlight:
buffer_load_dwordx4 v[28:31], v86, s[72:75], s38 offen sc1
buffer_load_dword v32, v86, s[72:75], s38 offen offset:268 sc1
s_waitcnt vmcnt(0)
v_add3_u32 v33, v28, v29, v30
v_add3_u32 v33, v33, v31, v32
v_cmp_ne_u32 vcc, s83, v33
s_nop 0
s_cmp_eq_u64 vcc, 0
s_cbranch_scc1 L_qfull
s_sub_u32 s50, s50, 1
s_cmp_lg_u32 s50, 0
s_cbranch_scc1 L_qlight
L_qfull:
s_lshl_b32 s79, s83, 2
s_mov_b32 s50, 400000
L_qpoll:
s_mov_b32 s37, s40
s_mov_b32 s38, s39
buffer_load_dwordx4 v[28:31], v85, s[72:75], s37 offen sc1
buffer_load_dword v44, v96, s[72:75], s38 offen sc1
s_add_u32 s37, s37, 4096
s_add_u32 s38, s38, 4096
buffer_load_dwordx4 v[32:35], v85, s[72:75], s37 offen sc1
buffer_load_dword v45, v96, s[72:75], s38 offen sc1
s_add_u32 s37, s37, 4096
s_add_u32 s38, s38, 4096
buffer_load_dwordx4 v[36:39], v85, s[72:75], s37 offen sc1
buffer_load_dword v46, v96, s[72:75], s38 offen sc1
s_add_u32 s37, s37, 4096
s_add_u32 s38, s38, 4096
buffer_load_dwordx4 v[40:43], v85, s[72:75], s37 offen sc1
buffer_load_dword v47, v96, s[72:75], s38 offen sc1
s_waitcnt vmcnt(0)
v_add3_u32 v92, v28, v29, v30
v_add3_u32 v92, v92, v31, v32
v_add3_u32 v92, v92, v33, v34
v_add3_u32 v92, v92, v35, v36
v_add3_u32 v92, v92, v37, v38
v_add3_u32 v92, v92, v39, v40
v_add3_u32 v92, v92, v41, v42
v_add3_u32 v92, v92, v43, v44
v_add3_u32 v92, v92, v45, v46
v_add_u32 v92, v92, v47
v_cmp_ne_u32 vcc, s79, v92
s_nop 0
s_cmp_eq_u64 vcc, 0
s_cbranch_scc1 L_qpoll_ok
s_mov_b64 exec, vcc
s_sub_u32 s50, s50, 1
s_cmp_lg_u32 s50, 0
s_cbranch_scc1 L_qpoll
L_qpoll_ok:
s_mov_b64 exec, -1
v_add_f32 v96, v28, v32
v_add_f32 v100, v36, v40
v_add_f32 v97, v29, v33
v_add_f32 v101, v37, v41
v_add_f32 v98, v30, v34
v_add_f32 v102, v38, v42
v_add_f32 v99, v31, v35
v_add_f32 v103, v39, v43
v_add_f32 v92, v96, v100
v_add_f32 v93, v97, v101
v_add_f32 v94, v98, v102
v_add_f32 v95, v99, v103
v_mov_b32 v96, v92
v_mov_b32 v97, v93
v_mov_b32 v98, v94
v_mov_b32 v99, v95
v_permlane32_swap_b32 v92, v96
v_permlane32_swap_b32 v93, v97
v_permlane32_swap_b32 v94, v98
v_permlane32_swap_b32 v95, v99
v_add_f32 v92, v92, v96
v_add_f32 v93, v93, v97
v_add_f32 v94, v94, v98
v_add_f32 v95, v95, v99
v_cvt_pk_bf16_f32 v96, v92, v93
v_cvt_pk_bf16_f32 v97, v94, v95
v_and_b32 v85, 1, v60
v_lshlrev_b32 v85, 3, v85
v_lshl_add_u32 v85, v61, 4, v85
s_mov_b32 exec_hi, 0
ds_write_b64 v85, v[96:97] offset:19456
s_mov_b64 exec, -1
s_waitcnt lgkmcnt(0)
v_mov_b32 v3, 11008
v_mov_b32 v127, 1
s_mov_b64 exec, 1
ds_add_u32 v3, v127
s_mov_b64 exec, -1
s_setprio 0
L_hstart:
s_waitcnt vmcnt(3)
s_add_u32 s42, s41, 229376
buffer_load_dwordx4 v[144:147], v81, s[60:63], s42 offen nt
s_waitcnt vmcnt(3)
s_add_u32 s42, s41, 286720
buffer_load_dwordx4 v[148:151], v81, s[60:63], s42 offen nt
s_waitcnt vmcnt(3)
s_add_u32 s42, s41, 344064
buffer_load_dwordx4 v[152:155], v81, s[60:63], s42 offen nt
s_waitcnt vmcnt(3)
s_add_u32 s42, s41, 401408
buffer_load_dwordx4 v[156:159], v81, s[60:63], s42 offen nt
s_waitcnt vmcnt(3)
s_add_u32 s42, s41, 458752
buffer_load_dwordx4 v[160:163], v81, s[60:63], s42 offen nt
s_waitcnt vmcnt(3)
s_add_u32 s42, s41, 516096
buffer_load_dwordx4 v[164:167], v81, s[60:63], s42 offen nt
s_waitcnt vmcnt(3)
s_add_u32 s42, s41, 573440
buffer_load_dwordx4 v[168:171], v81, s[60:63], s42 offen nt
s_waitcnt vmcnt(3)
s_add_u32 s42, s41, 630784
buffer_load_dwordx4 v[172:175], v81, s[60:63], s42 offen nt
s_waitcnt vmcnt(3)
s_add_u32 s42, s41, 688128
buffer_load_dwordx4 v[176:179], v81, s[60:63], s42 offen nt
s_waitcnt vmcnt(3)
s_add_u32 s42, s41, 745472
buffer_load_dwordx4 v[180:183], v81, s[60:63], s42 offen nt
s_waitcnt vmcnt(3)
s_add_u32 s42, s41, 802816
buffer_load_dwordx4 v[184:187], v81, s[60:63], s42 offen nt
s_waitcnt vmcnt(3)
s_add_u32 s42, s41, 860160
buffer_load_dwordx4 v[188:191], v81, s[60:63], s42 offen nt
s_waitcnt vmcnt(3)
s_add_u32 s42, s43, 0
buffer_load_dwordx4 v[192:195], v82, s[64:67], s42 offen nt
s_waitcnt vmcnt(3)
s_add_u32 s42, s43, 8192
buffer_load_dwordx4 v[196:199], v82, s[64:67], s42 offen nt
s_waitcnt vmcnt(3)
s_add_u32 s42, s43, 16384
buffer_load_dwordx4 v[200:203], v82, s[64:67], s42 offen nt
s_waitcnt vmcnt(3)
s_add_u32 s42, s43, 24576
buffer_load_dwordx4 v[204:207], v82, s[64:67], s42 offen nt
s_waitcnt vmcnt(3)
s_add_u32 s42, s43, 32768
buffer_load_dwordx4 v[208:211], v83, s[64:67], s42 offen nt
s_waitcnt vmcnt(3)
s_add_u32 s42, s43, 40960
buffer_load_dwordx4 v[212:215], v83, s[64:67], s42 offen nt
s_waitcnt vmcnt(3)
s_add_u32 s42, s43, 49152
buffer_load_dwordx4 v[216:219], v83, s[64:67], s42 offen nt
s_waitcnt vmcnt(3)
s_add_u32 s42, s43, 57344
buffer_load_dwordx4 v[220:223], v83, s[64:67], s42 offen nt
s_waitcnt vmcnt(3)
s_add_u32 s42, s43, 0
buffer_load_dwordx4 v[224:227], v82, s[68:71], s42 offen nt
s_waitcnt vmcnt(3)
s_add_u32 s42, s43, 8192
buffer_load_dwordx4 v[228:231], v82, s[68:71], s42 offen nt
s_waitcnt vmcnt(3)
s_add_u32 s42, s43, 16384
buffer_load_dwordx4 v[232:235], v82, s[68:71], s42 offen nt
s_waitcnt vmcnt(3)
s_add_u32 s42, s43, 24576
buffer_load_dwordx4 v[236:239], v82, s[68:71], s42 offen nt
s_waitcnt vmcnt(3)
s_add_u32 s42, s43, 32768
buffer_load_dwordx4 v[240:243], v82, s[68:71], s42 offen nt
s_waitcnt vmcnt(3)
s_add_u32 s42, s43, 40960
buffer_load_dwordx4 v[244:247], v82, s[68:71], s42 offen nt
s_waitcnt vmcnt(3)
s_add_u32 s42, s43, 49152
buffer_load_dwordx4 v[248:251], v82, s[68:71], s42 offen nt
s_waitcnt vmcnt(3)
s_add_u32 s42, s43, 57344
buffer_load_dwordx4 v[252:255], v82, s[68:71], s42 offen nt
v_mov_b32 v16, 0
v_mov_b32 v17, 0
v_mov_b32 v18, 0
v_mov_b32 v19, 0
v_mov_b32 v20, 0
v_mov_b32 v21, 0
v_mov_b32 v22, 0
v_mov_b32 v23, 0
s_lshl_b32 s37, s54, 8
s_lshr_b32 s38, s36, 1
s_lshl_b32 s38, s38, 7
s_add_u32 s37, s37, s38
v_add_u32 v85, s37, v65
v_mov_b32 v3, 11040
s_mov_b32 s51, 1600000
Lw_7:
ds_read_b32 v127, v3
s_waitcnt lgkmcnt(0)
v_readfirstlane_b32 s37, v127
s_nop 0
s_cmp_ge_u32 s37, 4
s_cbranch_scc1 Lw_7_ok
s_sub_u32 s51, s51, 1
s_cmp_lg_u32 s51, 0
s_cbranch_scc1 Lw_7
Lw_7_ok:
ds_read_b128 v[44:47], v85 offset:0
ds_read_b128 v[48:51], v85 offset:16
ds_read_b128 v[52:55], v85 offset:32
ds_read_b128 v[56:59], v85 offset:48
s_waitcnt lgkmcnt(0)
v_and_b32 v8, v44, v4
v_and_b32 v9, v44, v5
v_and_b32 v10, v44, v6
v_and_b32 v11, v44, v7
s_nop 1
v_mfma_f32_16x16x32_bf16 v[16:19], v[8:11], v[128:131], v[16:19]
v_and_b32 v12, v45, v4
v_and_b32 v13, v45, v5
v_and_b32 v14, v45, v6
v_and_b32 v15, v45, v7
s_nop 1
v_mfma_f32_16x16x32_bf16 v[20:23], v[12:15], v[128:131], v[20:23]
v_and_b32 v8, v46, v4
v_and_b32 v9, v46, v5
v_and_b32 v10, v46, v6
v_and_b32 v11, v46, v7
s_nop 1
v_mfma_f32_16x16x32_bf16 v[16:19], v[8:11], v[132:135], v[16:19]
v_and_b32 v12, v47, v4
v_and_b32 v13, v47, v5
v_and_b32 v14, v47, v6
v_and_b32 v15, v47, v7
s_nop 1
v_mfma_f32_16x16x32_bf16 v[20:23], v[12:15], v[132:135], v[20:23]
v_and_b32 v8, v48, v4
v_and_b32 v9, v48, v5
v_and_b32 v10, v48, v6
v_and_b32 v11, v48, v7
s_nop 1
v_mfma_f32_16x16x32_bf16 v[16:19], v[8:11], v[136:139], v[16:19]
v_and_b32 v12, v49, v4
v_and_b32 v13, v49, v5
v_and_b32 v14, v49, v6
v_and_b32 v15, v49, v7
s_nop 1
v_mfma_f32_16x16x32_bf16 v[20:23], v[12:15], v[136:139], v[20:23]
v_and_b32 v8, v50, v4
v_and_b32 v9, v50, v5
v_and_b32 v10, v50, v6
v_and_b32 v11, v50, v7
s_nop 1
v_mfma_f32_16x16x32_bf16 v[16:19], v[8:11], v[140:143], v[16:19]
v_and_b32 v12, v51, v4
v_and_b32 v13, v51, v5
v_and_b32 v14, v51, v6
v_and_b32 v15, v51, v7
s_nop 1
v_mfma_f32_16x16x32_bf16 v[20:23], v[12:15], v[140:143], v[20:23]
v_and_b32 v8, v52, v4
v_and_b32 v9, v52, v5
v_and_b32 v10, v52, v6
v_and_b32 v11, v52, v7
s_nop 1
v_mfma_f32_16x16x32_bf16 v[16:19], v[8:11], v[144:147], v[16:19]
v_and_b32 v12, v53, v4
v_and_b32 v13, v53, v5
v_and_b32 v14, v53, v6
v_and_b32 v15, v53, v7
s_nop 1
v_mfma_f32_16x16x32_bf16 v[20:23], v[12:15], v[144:147], v[20:23]
v_and_b32 v8, v54, v4
v_and_b32 v9, v54, v5
v_and_b32 v10, v54, v6
v_and_b32 v11, v54, v7
s_nop 1
v_mfma_f32_16x16x32_bf16 v[16:19], v[8:11], v[148:151], v[16:19]
v_and_b32 v12, v55, v4
v_and_b32 v13, v55, v5
v_and_b32 v14, v55, v6
v_and_b32 v15, v55, v7
s_nop 1
v_mfma_f32_16x16x32_bf16 v[20:23], v[12:15], v[148:151], v[20:23]
v_and_b32 v8, v56, v4
v_and_b32 v9, v56, v5
v_and_b32 v10, v56, v6
v_and_b32 v11, v56, v7
s_nop 1
v_mfma_f32_16x16x32_bf16 v[16:19], v[8:11], v[152:155], v[16:19]
v_and_b32 v12, v57, v4
v_and_b32 v13, v57, v5
v_and_b32 v14, v57, v6
v_and_b32 v15, v57, v7
s_nop 1
v_mfma_f32_16x16x32_bf16 v[20:23], v[12:15], v[152:155], v[20:23]
v_and_b32 v8, v58, v4
v_and_b32 v9, v58, v5
v_and_b32 v10, v58, v6
v_and_b32 v11, v58, v7
s_nop 1
v_mfma_f32_16x16x32_bf16 v[16:19], v[8:11], v[156:159], v[16:19]
v_and_b32 v12, v59, v4
v_and_b32 v13, v59, v5
v_and_b32 v14, v59, v6
v_and_b32 v15, v59, v7
s_nop 1
v_mfma_f32_16x16x32_bf16 v[20:23], v[12:15], v[156:159], v[20:23]
ds_read_b128 v[44:47], v85 offset:64
ds_read_b128 v[48:51], v85 offset:80
ds_read_b128 v[52:55], v85 offset:96
ds_read_b128 v[56:59], v85 offset:112
s_waitcnt lgkmcnt(0)
v_and_b32 v8, v44, v4
v_and_b32 v9, v44, v5
v_and_b32 v10, v44, v6
v_and_b32 v11, v44, v7
s_nop 1
v_mfma_f32_16x16x32_bf16 v[16:19], v[8:11], v[160:163], v[16:19]
v_and_b32 v12, v45, v4
v_and_b32 v13, v45, v5
v_and_b32 v14, v45, v6
v_and_b32 v15, v45, v7
s_nop 1
v_mfma_f32_16x16x32_bf16 v[20:23], v[12:15], v[160:163], v[20:23]
v_and_b32 v8, v46, v4
v_and_b32 v9, v46, v5
v_and_b32 v10, v46, v6
v_and_b32 v11, v46, v7
s_nop 1
v_mfma_f32_16x16x32_bf16 v[16:19], v[8:11], v[164:167], v[16:19]
v_and_b32 v12, v47, v4
v_and_b32 v13, v47, v5
v_and_b32 v14, v47, v6
v_and_b32 v15, v47, v7
s_nop 1
v_mfma_f32_16x16x32_bf16 v[20:23], v[12:15], v[164:167], v[20:23]
v_and_b32 v8, v48, v4
v_and_b32 v9, v48, v5
v_and_b32 v10, v48, v6
v_and_b32 v11, v48, v7
s_nop 1
v_mfma_f32_16x16x32_bf16 v[16:19], v[8:11], v[168:171], v[16:19]
v_and_b32 v12, v49, v4
v_and_b32 v13, v49, v5
v_and_b32 v14, v49, v6
v_and_b32 v15, v49, v7
s_nop 1
v_mfma_f32_16x16x32_bf16 v[20:23], v[12:15], v[168:171], v[20:23]
v_and_b32 v8, v50, v4
v_and_b32 v9, v50, v5
v_and_b32 v10, v50, v6
v_and_b32 v11, v50, v7
s_nop 1
v_mfma_f32_16x16x32_bf16 v[16:19], v[8:11], v[172:175], v[16:19]
v_and_b32 v12, v51, v4
v_and_b32 v13, v51, v5
v_and_b32 v14, v51, v6
v_and_b32 v15, v51, v7
s_nop 1
v_mfma_f32_16x16x32_bf16 v[20:23], v[12:15], v[172:175], v[20:23]
v_and_b32 v8, v52, v4
v_and_b32 v9, v52, v5
v_and_b32 v10, v52, v6
v_and_b32 v11, v52, v7
s_nop 1
v_mfma_f32_16x16x32_bf16 v[16:19], v[8:11], v[176:179], v[16:19]
v_and_b32 v12, v53, v4
v_and_b32 v13, v53, v5
v_and_b32 v14, v53, v6
v_and_b32 v15, v53, v7
s_nop 1
v_mfma_f32_16x16x32_bf16 v[20:23], v[12:15], v[176:179], v[20:23]
v_and_b32 v8, v54, v4
v_and_b32 v9, v54, v5
v_and_b32 v10, v54, v6
v_and_b32 v11, v54, v7
s_nop 1
v_mfma_f32_16x16x32_bf16 v[16:19], v[8:11], v[180:183], v[16:19]
v_and_b32 v12, v55, v4
v_and_b32 v13, v55, v5
v_and_b32 v14, v55, v6
v_and_b32 v15, v55, v7
s_nop 1
v_mfma_f32_16x16x32_bf16 v[20:23], v[12:15], v[180:183], v[20:23]
v_and_b32 v8, v56, v4
v_and_b32 v9, v56, v5
v_and_b32 v10, v56, v6
v_and_b32 v11, v56, v7
s_nop 1
v_mfma_f32_16x16x32_bf16 v[16:19], v[8:11], v[184:187], v[16:19]
v_and_b32 v12, v57, v4
v_and_b32 v13, v57, v5
v_and_b32 v14, v57, v6
v_and_b32 v15, v57, v7
s_nop 1
v_mfma_f32_16x16x32_bf16 v[20:23], v[12:15], v[184:187], v[20:23]
v_and_b32 v8, v58, v4
v_and_b32 v9, v58, v5
v_and_b32 v10, v58, v6
v_and_b32 v11, v58, v7
s_nop 1
v_mfma_f32_16x16x32_bf16 v[16:19], v[8:11], v[188:191], v[16:19]
v_and_b32 v12, v59, v4
v_and_b32 v13, v59, v5
v_and_b32 v14, v59, v6
v_and_b32 v15, v59, v7
s_nop 1
v_mfma_f32_16x16x32_bf16 v[20:23], v[12:15], v[188:191], v[20:23]
s_nop 7
v_add_f32_dpp v16, v20, v16 row_ror:8 row_mask:0xf bank_mask:0xf
v_add_f32_dpp v17, v21, v17 row_ror:8 row_mask:0xf bank_mask:0xf
v_add_f32_dpp v18, v22, v18 row_ror:8 row_mask:0xf bank_mask:0xf
v_add_f32_dpp v19, v23, v19 row_ror:8 row_mask:0xf bank_mask:0xf
s_and_b32 s37, s36, 1
s_lshl_b32 s37, s37, 10
v_add_u32 v84, s37, v2
s_cmp_lt_u32 s36, 2
s_cbranch_scc1 L_f1_keep
ds_write_b128 v84, v[16:19] offset:19968
s_waitcnt lgkmcnt(0)
v_mov_b32 v3, 11012
v_mov_b32 v127, 1
s_mov_b64 exec, 1
ds_add_u32 v3, v127
s_mov_b64 exec, -1
L_f1_keep:
s_cmp_lt_u32 s36, 2
s_cbranch_scc0 L_f1_done
v_mov_b32 v3, 11012
s_mov_b32 s51, 1600000
Lw_8:
ds_read_b32 v127, v3
s_waitcnt lgkmcnt(0)
v_readfirstlane_b32 s37, v127
s_nop 0
s_cmp_ge_u32 s37, 2
s_cbranch_scc1 Lw_8_ok
s_sub_u32 s51, s51, 1
s_cmp_lg_u32 s51, 0
s_cbranch_scc1 Lw_8
Lw_8_ok:
ds_read_b128 v[20:23], v84 offset:19968
s_waitcnt lgkmcnt(0)
v_add_f32 v16, v16, v20
v_add_f32 v17, v17, v21
v_add_f32 v18, v18, v22
v_add_f32 v19, v19, v23
s_cmp_eq_u32 s36, 0
s_cbranch_scc1 L_f1_h0
ds_write_b128 v2, v[16:19] offset:22016
s_waitcnt lgkmcnt(0)
v_mov_b32 v3, 11016
v_mov_b32 v127, 1
s_mov_b64 exec, 1
ds_add_u32 v3, v127
s_mov_b64 exec, -1
s_branch L_f1_done
L_f1_h0:
v_and_b32 v85, 7, v61
v_lshl_add_u32 v85, v60, 4, v85
v_lshlrev_b32 v85, 4, v85
v_mov_b32 v3, 11016
s_mov_b32 s51, 1600000
Lw_9:
ds_read_b32 v127, v3
s_waitcnt lgkmcnt(0)
v_readfirstlane_b32 s37, v127
s_nop 0
s_cmp_ge_u32 s37, 1
s_cbranch_scc1 Lw_9_ok
s_sub_u32 s51, s51, 1
s_cmp_lg_u32 s51, 0
s_cbranch_scc1 Lw_9
Lw_9_ok:
ds_read_b128 v[20:23], v85 offset:22016
v_cmp_lt_u32 vcc, 7, v61
s_waitcnt lgkmcnt(0)
s_nop 0
v_cndmask_b32 v16, v16, v20, vcc
v_cndmask_b32 v17, v17, v21, vcc
v_cndmask_b32 v18, v18, v22, vcc
v_cndmask_b32 v19, v19, v23, vcc
v_and_b32 v86, 7, v61
v_cmp_gt_u32 vcc, 7, v86
s_nop 1
v_cndmask_b32 v16, 0, v16, vcc
v_cndmask_b32 v17, 0, v17, vcc
v_cndmask_b32 v18, 0, v18, vcc
v_cndmask_b32 v19, 0, v19, vcc
v_add3_u32 v20, v16, v17, v18
v_add_u32 v20, v20, v19
s_nop 1
v_add_u32_dpp v20, v20, v20 row_ror:8 row_mask:0xf bank_mask:0xf
s_nop 1
v_add_u32_dpp v20, v20, v20 row_ror:4 row_mask:0xf bank_mask:0xf
s_nop 1
v_add_u32_dpp v20, v20, v20 row_ror:2 row_mask:0xf bank_mask:0xf
s_nop 1
v_add_u32_dpp v20, v20, v20 row_ror:1 row_mask:0xf bank_mask:0xf
v_sub_u32 v20, s83, v20
v_cmp_eq_u32 vcc, 15, v61
s_nop 1
v_cndmask_b32 v16, v16, v20, vcc
s_lshl_b32 s37, s53, 2
s_add_u32 s37, s37, s54
s_lshl_b32 s37, s37, 10
s_add_u32 s37, s37, 524288
buffer_store_dwordx4 v[16:19], v2, s[72:75], s37 offen sc1
v_mov_b32 v3, 11048
s_mov_b32 s51, 1600000
Lw_10:
ds_read_b32 v127, v3
s_waitcnt lgkmcnt(0)
v_readfirstlane_b32 s37, v127
s_nop 0
s_cmp_ge_u32 s37, 24
s_cbranch_scc1 Lw_10_ok
s_sleep 32
s_sub_u32 s51, s51, 1
s_cmp_lg_u32 s51, 0
s_cbranch_scc1 Lw_10
Lw_10_ok:
s_lshl_b32 s79, s83, 3
s_mov_b32 s50, 400000
L_x1poll:
s_lshl_b32 s37, s32, 13
s_add_u32 s37, s37, 524288
buffer_load_dwordx4 v[128:131], v2, s[72:75], s37 offen offset:0 sc1
buffer_load_dwordx4 v[132:135], v2, s[72:75], s37 offen offset:1024 sc1
buffer_load_dwordx4 v[136:139], v2, s[72:75], s37 offen offset:2048 sc1
buffer_load_dwordx4 v[140:143], v2, s[72:75], s37 offen offset:3072 sc1
s_add_u32 s37, s37, 4096
buffer_load_dwordx4 v[144:147], v2, s[72:75], s37 offen offset:0 sc1
buffer_load_dwordx4 v[148:151], v2, s[72:75], s37 offen offset:1024 sc1
buffer_load_dwordx4 v[152:155], v2, s[72:75], s37 offen offset:2048 sc1
buffer_load_dwordx4 v[156:159], v2, s[72:75], s37 offen offset:3072 sc1
s_waitcnt vmcnt(0)
v_add3_u32 v28, v128, v129, v130
v_add3_u32 v28, v28, v131, v132
v_add3_u32 v28, v28, v133, v134
v_add3_u32 v28, v28, v135, v136
v_add3_u32 v28, v28, v137, v138
v_add3_u32 v28, v28, v139, v140
v_add3_u32 v28, v28, v141, v142
v_add3_u32 v28, v28, v143, v144
v_add3_u32 v28, v28, v145, v146
v_add3_u32 v28, v28, v147, v148
v_add3_u32 v28, v28, v149, v150
v_add3_u32 v28, v28, v151, v152
v_add3_u32 v28, v28, v153, v154
v_add3_u32 v28, v28, v155, v156
v_add3_u32 v28, v28, v157, v158
v_add_u32 v28, v28, v159
s_nop 1
v_add_u32_dpp v28, v28, v28 row_ror:8 row_mask:0xf bank_mask:0xf
s_nop 1
v_add_u32_dpp v28, v28, v28 row_ror:4 row_mask:0xf bank_mask:0xf
s_nop 1
v_add_u32_dpp v28, v28, v28 row_ror:2 row_mask:0xf bank_mask:0xf
s_nop 1
v_add_u32_dpp v28, v28, v28 row_ror:1 row_mask:0xf bank_mask:0xf
v_cmp_ne_u32 vcc, s79, v28
s_nop 0
s_cmp_eq_u64 vcc, 0
s_cbranch_scc1 L_x1poll_ok
s_sleep 32
s_sub_u32 s50, s50, 1
s_cmp_lg_u32 s50, 0
s_cbranch_scc1 L_x1poll
L_x1poll_ok:
s_mov_b64 exec, -1
v_add_f32 v28, v128, v132
v_add_f32 v36, v136, v140
v_add_f32 v29, v129, v133
v_add_f32 v37, v137, v141
v_add_f32 v30, v130, v134
v_add_f32 v38, v138, v142
v_add_f32 v31, v131, v135
v_add_f32 v39, v139, v143
v_add_f32 v28, v28, v36
v_add_f32 v29, v29, v37
v_add_f32 v30, v30, v38
v_add_f32 v31, v31, v39
v_add_f32 v32, v144, v148
v_add_f32 v36, v152, v156
v_add_f32 v33, v145, v149
v_add_f32 v37, v153, v157
v_add_f32 v34, v146, v150
v_add_f32 v38, v154, v158
v_add_f32 v35, v147, v151
v_add_f32 v39, v155, v159
v_add_f32 v32, v32, v36
v_add_f32 v33, v33, v37
v_add_f32 v34, v34, v38
v_add_f32 v35, v35, v39
v_mov_b32_dpp v44, v28 row_ror:8 row_mask:0xf bank_mask:0xf
v_mov_b32_dpp v45, v29 row_ror:8 row_mask:0xf bank_mask:0xf
v_mov_b32_dpp v46, v30 row_ror:8 row_mask:0xf bank_mask:0xf
v_mov_b32_dpp v47, v31 row_ror:8 row_mask:0xf bank_mask:0xf
v_mov_b32_dpp v48, v32 row_ror:8 row_mask:0xf bank_mask:0xf
v_mov_b32_dpp v49, v33 row_ror:8 row_mask:0xf bank_mask:0xf
v_mov_b32_dpp v50, v34 row_ror:8 row_mask:0xf bank_mask:0xf
v_mov_b32_dpp v51, v35 row_ror:8 row_mask:0xf bank_mask:0xf
v_cmp_gt_u32 vcc, 7, v61
s_nop 1
v_cndmask_b32 v28, 0, v28, vcc
v_cndmask_b32 v44, 0, v44, vcc
v_cndmask_b32 v29, 0, v29, vcc
v_cndmask_b32 v45, 0, v45, vcc
v_cndmask_b32 v30, 0, v30, vcc
v_cndmask_b32 v46, 0, v46, vcc
v_cndmask_b32 v31, 0, v31, vcc
v_cndmask_b32 v47, 0, v47, vcc
v_cndmask_b32 v32, 0, v32, vcc
v_cndmask_b32 v48, 0, v48, vcc
v_cndmask_b32 v33, 0, v33, vcc
v_cndmask_b32 v49, 0, v49, vcc
v_cndmask_b32 v34, 0, v34, vcc
v_cndmask_b32 v50, 0, v50, vcc
v_cndmask_b32 v35, 0, v35, vcc
v_cndmask_b32 v51, 0, v51, vcc
v_lshrrev_b32 v85, 1, v60
v_mul_u32_u24 v85, 576, v85
v_and_b32 v86, 1, v60
v_lshl_add_u32 v86, v61, 1, v86
v_lshl_add_u32 v85, v86, 2, v85
v_cvt_pk_bf16_f32 v28, v28, v28
v_and_b32 v28, 0xffff0000, v28
v_cvt_pk_bf16_f32 v44, v44, v44
v_and_b32 v44, 0xffff0000, v44
v_mul_f32 v37, 0xbfb8aa3b, v28
v_exp_f32 v37, v37
s_nop 0
v_add_f32 v37, 1.0, v37
v_rcp_f32 v38, v37
s_nop 0
v_mul_f32 v36, v28, v38
v_cvt_pk_bf16_f32 v36, v36, v36
v_and_b32 v36, 0xffff0000, v36
v_mul_f32 v36, v36, v44
v_cvt_pk_bf16_f32 v28, v36, v36
v_cvt_pk_bf16_f32 v29, v29, v29
v_and_b32 v29, 0xffff0000, v29
v_cvt_pk_bf16_f32 v45, v45, v45
v_and_b32 v45, 0xffff0000, v45
v_mul_f32 v37, 0xbfb8aa3b, v29
v_exp_f32 v37, v37
s_nop 0
v_add_f32 v37, 1.0, v37
v_rcp_f32 v38, v37
s_nop 0
v_mul_f32 v36, v29, v38
v_cvt_pk_bf16_f32 v36, v36, v36
v_and_b32 v36, 0xffff0000, v36
v_mul_f32 v36, v36, v45
v_cvt_pk_bf16_f32 v29, v36, v36
v_cvt_pk_bf16_f32 v30, v30, v30
v_and_b32 v30, 0xffff0000, v30
v_cvt_pk_bf16_f32 v46, v46, v46
v_and_b32 v46, 0xffff0000, v46
v_mul_f32 v37, 0xbfb8aa3b, v30
v_exp_f32 v37, v37
s_nop 0
v_add_f32 v37, 1.0, v37
v_rcp_f32 v38, v37
s_nop 0
v_mul_f32 v36, v30, v38
v_cvt_pk_bf16_f32 v36, v36, v36
v_and_b32 v36, 0xffff0000, v36
v_mul_f32 v36, v36, v46
v_cvt_pk_bf16_f32 v30, v36, v36
v_cvt_pk_bf16_f32 v31, v31, v31
v_and_b32 v31, 0xffff0000, v31
v_cvt_pk_bf16_f32 v47, v47, v47
v_and_b32 v47, 0xffff0000, v47
v_mul_f32 v37, 0xbfb8aa3b, v31
v_exp_f32 v37, v37
s_nop 0
v_add_f32 v37, 1.0, v37
v_rcp_f32 v38, v37
s_nop 0
v_mul_f32 v36, v31, v38
v_cvt_pk_bf16_f32 v36, v36, v36
v_and_b32 v36, 0xffff0000, v36
v_mul_f32 v36, v36, v47
v_cvt_pk_bf16_f32 v31, v36, v36
s_mov_b32 exec_lo, 0x7f007f
s_mov_b32 exec_hi, 0x7f007f
ds_write_b32 v85, v28 offset:8320
ds_write_b32 v85, v29 offset:8464
ds_write_b32 v85, v30 offset:8608
ds_write_b32 v85, v31 offset:8752
s_mov_b64 exec, -1
v_cvt_pk_bf16_f32 v32, v32, v32
v_and_b32 v32, 0xffff0000, v32
v_cvt_pk_bf16_f32 v48, v48, v48
v_and_b32 v48, 0xffff0000, v48
v_mul_f32 v37, 0xbfb8aa3b, v32
v_exp_f32 v37, v37
s_nop 0
v_add_f32 v37, 1.0, v37
v_rcp_f32 v38, v37
s_nop 0
v_mul_f32 v36, v32, v38
v_cvt_pk_bf16_f32 v36, v36, v36
v_and_b32 v36, 0xffff0000, v36
v_mul_f32 v36, v36, v48
v_cvt_pk_bf16_f32 v32, v36, v36
v_cvt_pk_bf16_f32 v33, v33, v33
v_and_b32 v33, 0xffff0000, v33
v_cvt_pk_bf16_f32 v49, v49, v49
v_and_b32 v49, 0xffff0000, v49
v_mul_f32 v37, 0xbfb8aa3b, v33
v_exp_f32 v37, v37
s_nop 0
v_add_f32 v37, 1.0, v37
v_rcp_f32 v38, v37
s_nop 0
v_mul_f32 v36, v33, v38
v_cvt_pk_bf16_f32 v36, v36, v36
v_and_b32 v36, 0xffff0000, v36
v_mul_f32 v36, v36, v49
v_cvt_pk_bf16_f32 v33, v36, v36
v_cvt_pk_bf16_f32 v34, v34, v34
v_and_b32 v34, 0xffff0000, v34
v_cvt_pk_bf16_f32 v50, v50, v50
v_and_b32 v50, 0xffff0000, v50
v_mul_f32 v37, 0xbfb8aa3b, v34
v_exp_f32 v37, v37
s_nop 0
v_add_f32 v37, 1.0, v37
v_rcp_f32 v38, v37
s_nop 0
v_mul_f32 v36, v34, v38
v_cvt_pk_bf16_f32 v36, v36, v36
v_and_b32 v36, 0xffff0000, v36
v_mul_f32 v36, v36, v50
v_cvt_pk_bf16_f32 v34, v36, v36
v_cvt_pk_bf16_f32 v35, v35, v35
v_and_b32 v35, 0xffff0000, v35
v_cvt_pk_bf16_f32 v51, v51, v51
v_and_b32 v51, 0xffff0000, v51
v_mul_f32 v37, 0xbfb8aa3b, v35
v_exp_f32 v37, v37
s_nop 0
v_add_f32 v37, 1.0, v37
v_rcp_f32 v38, v37
s_nop 0
v_mul_f32 v36, v35, v38
v_cvt_pk_bf16_f32 v36, v36, v36
v_and_b32 v36, 0xffff0000, v36
v_mul_f32 v36, v36, v51
v_cvt_pk_bf16_f32 v35, v36, v36
s_mov_b32 exec_lo, 0x1ff01ff
s_mov_b32 exec_hi, 0x1ff01ff
ds_write_b32 v85, v32 offset:8376
ds_write_b32 v85, v33 offset:8520
ds_write_b32 v85, v34 offset:8664
ds_write_b32 v85, v35 offset:8808
s_mov_b64 exec, -1
s_waitcnt lgkmcnt(0)
v_mov_b32 v3, 11020
v_mov_b32 v127, 1
s_mov_b64 exec, 1
ds_add_u32 v3, v127
s_mov_b64 exec, -1
L_f1_done:
v_mov_b32 v3, 11020
s_mov_b32 s51, 1600000
Lw_11:
ds_read_b32 v127, v3
s_waitcnt lgkmcnt(0)
v_readfirstlane_b32 s37, v127
s_nop 0
s_cmp_ge_u32 s37, 1
s_cbranch_scc1 Lw_11_ok
s_sleep 32
s_sub_u32 s51, s51, 1
s_cmp_lg_u32 s51, 0
s_cbranch_scc1 Lw_11
Lw_11_ok:
v_mul_u32_u24 v85, 144, v66
s_lshl_b32 s37, s36, 5
v_add_u32 v85, s37, v85
ds_read_b128 v[44:47], v85 offset:8320
ds_read_b128 v[48:51], v85 offset:8336
v_mov_b32 v16, 0
v_mov_b32 v17, 0
v_mov_b32 v18, 0
v_mov_b32 v19, 0
s_waitcnt vmcnt(0) lgkmcnt(0)
v_and_b32 v8, v44, v4
v_and_b32 v9, v44, v5
v_and_b32 v10, v44, v6
v_and_b32 v11, v44, v7
s_nop 1
v_mfma_f32_16x16x32_bf16 v[16:19], v[8:11], v[192:195], v[16:19]
v_and_b32 v12, v45, v4
v_and_b32 v13, v45, v5
v_and_b32 v14, v45, v6
v_and_b32 v15, v45, v7
s_nop 1
v_mfma_f32_16x16x32_bf16 v[16:19], v[12:15], v[196:199], v[16:19]
v_and_b32 v8, v46, v4
v_and_b32 v9, v46, v5
v_and_b32 v10, v46, v6
v_and_b32 v11, v46, v7
s_nop 1
v_mfma_f32_16x16x32_bf16 v[16:19], v[8:11], v[200:203], v[16:19]
v_and_b32 v12, v47, v4
v_and_b32 v13, v47, v5
v_and_b32 v14, v47, v6
v_and_b32 v15, v47, v7
s_nop 1
v_mfma_f32_16x16x32_bf16 v[16:19], v[12:15], v[204:207], v[16:19]
v_and_b32 v8, v48, v4
v_and_b32 v9, v48, v5
v_and_b32 v10, v48, v6
v_and_b32 v11, v48, v7
s_nop 1
v_mfma_f32_16x16x32_bf16 v[16:19], v[8:11], v[208:211], v[16:19]
v_and_b32 v12, v49, v4
v_and_b32 v13, v49, v5
v_and_b32 v14, v49, v6
v_and_b32 v15, v49, v7
s_nop 1
v_mfma_f32_16x16x32_bf16 v[16:19], v[12:15], v[212:215], v[16:19]
v_and_b32 v8, v50, v4
v_and_b32 v9, v50, v5
v_and_b32 v10, v50, v6
v_and_b32 v11, v50, v7
s_nop 1
v_mfma_f32_16x16x32_bf16 v[16:19], v[8:11], v[216:219], v[16:19]
v_and_b32 v12, v51, v4
v_and_b32 v13, v51, v5
v_and_b32 v14, v51, v6
v_and_b32 v15, v51, v7
s_nop 1
v_mfma_f32_16x16x32_bf16 v[16:19], v[12:15], v[220:223], v[16:19]
s_lshl_b32 s37, s36, 10
v_add_u32 v84, s37, v2
v_lshrrev_b32 v87, 1, v60
v_lshlrev_b32 v87, 9, v87
v_and_b32 v86, 1, v60
v_lshl_add_u32 v87, v86, 4, v87
v_lshl_add_u32 v87, v61, 5, v87
v_lshrrev_b32 v117, 2, v87
s_lshr_b32 s81, s32, 3
v_lshlrev_b32 v88, 10, v60
v_bfe_u32 v86, v1, 3, 1
v_lshl_add_u32 v88, v86, 9, v88
v_and_b32 v89, 7, v1
v_lshl_add_u32 v88, v89, 4, v88
v_lshlrev_b32 v90, 11, v86
v_lshl_add_u32 v90, v89, 3, v90
s_lshl_b32 s37, s33, 8
s_lshl_b32 s38, s81, 6
s_add_u32 s37, s37, s38
v_add_u32 v90, s37, v90
s_and_b32 s37, s32, 7
s_cmp_eq_u32 s37, s33
s_cselect_b32 s80, 1, 0
s_cmp_eq_u32 s36, 0
s_cbranch_scc1 L_f2_h0
ds_write_b128 v84, v[16:19] offset:19968
s_waitcnt lgkmcnt(0)
v_mov_b32 v3, 11024
v_mov_b32 v127, 1
s_mov_b64 exec, 1
ds_add_u32 v3, v127
s_mov_b64 exec, -1
s_branch L_tail
L_f2_h0:
v_mov_b32 v3, 11024
s_mov_b32 s51, 1600000
Lw_12:
ds_read_b32 v127, v3
s_waitcnt lgkmcnt(0)
v_readfirstlane_b32 s37, v127
s_nop 0
s_cmp_ge_u32 s37, 3
s_cbranch_scc1 Lw_12_ok
s_sub_u32 s51, s51, 1
s_cmp_lg_u32 s51, 0
s_cbranch_scc1 Lw_12
Lw_12_ok:
ds_read_b128 v[32:35], v2 offset:20992
ds_read_b128 v[36:39], v2 offset:22016
ds_read_b128 v[40:43], v2 offset:23040
s_waitcnt lgkmcnt(0)
v_add_f32 v16, v16, v32
v_add_f32 v16, v16, v36
v_add_f32 v16, v16, v40
v_add_f32 v17, v17, v33
v_add_f32 v17, v17, v37
v_add_f32 v17, v17, v41
v_add_f32 v18, v18, v34
v_add_f32 v18, v18, v38
v_add_f32 v18, v18, v42
v_add_f32 v19, v19, v35
v_add_f32 v19, v19, v39
v_add_f32 v19, v19, v43
v_mov_b32 v28, -1
v_mov_b32 v29, -1
v_mov_b32 v30, -1
v_mov_b32 v31, -1
ds_write_b128 v2, v[28:31] offset:20992
ds_write_b128 v2, v[28:31] offset:22016
ds_write_b128 v2, v[28:31] offset:23040
v_add3_u32 v116, v16, v17, v18
v_add_u32 v116, v116, v19
v_sub_u32 v116, s83, v116
v_lshlrev_b32 v117, 2, v1
ds_write_b128 v2, v[16:19] offset:11264
ds_write_b32 v117, v116 offset:12288
s_waitcnt lgkmcnt(0)
v_mov_b32 v3, 11060
v_mov_b32 v127, 1
s_mov_b64 exec, 1
ds_add_u32 v3, v127
s_mov_b64 exec, -1
L_xm:
v_mov_b32 v3, 11028
s_mov_b32 s51, 1600000
Lw_13:
ds_read_b32 v127, v3
s_waitcnt lgkmcnt(0)
v_readfirstlane_b32 s37, v127
s_nop 0
s_cmp_ge_u32 s37, 4
s_cbranch_scc1 Lw_13_ok
s_sleep 4
s_sub_u32 s51, s51, 1
s_cmp_lg_u32 s51, 0
s_cbranch_scc1 Lw_13
Lw_13_ok:
s_setprio 2
v_mov_b32 v3, 0
ds_read_b128 v[28:31], v3 offset:19712
ds_read_b128 v[32:35], v3 offset:19728
s_waitcnt lgkmcnt(0)
v_max_f32 v36, v28, v30
v_max3_f32 v36, v36, v32, v34
v_sub_f32 v38, v28, v36
v_mul_f32 v38, 0x3fb8aa3b, v38
v_exp_f32 v38, v38
v_sub_f32 v39, v30, v36
v_mul_f32 v39, 0x3fb8aa3b, v39
v_exp_f32 v39, v39
v_sub_f32 v40, v32, v36
v_mul_f32 v40, 0x3fb8aa3b, v40
v_exp_f32 v40, v40
v_sub_f32 v41, v34, v36
v_mul_f32 v41, 0x3fb8aa3b, v41
v_exp_f32 v41, v41
v_mul_f32 v37, v38, v29
v_fmac_f32 v37, v39, v31
v_fmac_f32 v37, v40, v33
v_fmac_f32 v37, v41, v35
s_lshl_b32 s37, s45, 7
s_add_u32 s37, s37, 4194304
v_mov_b32 v3, 0
s_mov_b64 exec, 1
buffer_store_dwordx2 v[36:37], v3, s[72:75], s37 offen sc1
s_mov_b64 exec, -1
v_and_b32 v85, 3, v1
v_lshlrev_b32 v85, 7, v85
s_lshl_b32 s38, s32, 3
s_lshl_b32 s37, s34, 2
s_add_u32 s38, s38, s37
s_lshl_b32 s38, s38, 7
s_add_u32 s38, s38, 4194304
s_mov_b32 s50, 400000
buffer_load_dwordx2 v[128:129], v85, s[72:75], s38 offen sc1
L_xmp_loop:
buffer_load_dwordx2 v[132:133], v85, s[72:75], s38 offen sc1
s_waitcnt vmcnt(1)
v_max_u32 v32, v128, v129
v_cmp_eq_u32 vcc, -1, v32
s_nop 0
s_cmp_eq_u64 vcc, 0
s_cbranch_scc1 L_xmp_okA
buffer_load_dwordx2 v[128:129], v85, s[72:75], s38 offen sc1
s_waitcnt vmcnt(1)
v_max_u32 v32, v132, v133
v_cmp_eq_u32 vcc, -1, v32
s_nop 0
s_cmp_eq_u64 vcc, 0
s_cbranch_scc1 L_xmp_okB
s_sub_u32 s50, s50, 1
s_cmp_lg_u32 s50, 0
s_cbranch_scc0 L_xmp_okB
s_branch L_xmp_loop
L_xmp_okB:
v_mov_b32 v28, v132
v_mov_b32 v29, v133
s_branch L_xmp_end
L_xmp_okA:
v_mov_b32 v28, v128
v_mov_b32 v29, v129
L_xmp_end:
s_nop 0
v_max_f32_dpp v30, v28, v28 quad_perm:[1,0,3,2] row_mask:0xf bank_mask:0xf
s_nop 1
v_max_f32_dpp v30, v30, v30 quad_perm:[2,3,0,1] row_mask:0xf bank_mask:0xf
v_sub_f32 v31, v28, v30
v_mul_f32 v31, 0x3fb8aa3b, v31
v_exp_f32 v31, v31
s_nop 0
v_mul_f32 v31, v31, v29
s_nop 1
v_add_f32_dpp v31, v31, v31 quad_perm:[1,0,3,2] row_mask:0xf bank_mask:0xf
s_nop 1
v_add_f32_dpp v31, v31, v31 quad_perm:[2,3,0,1] row_mask:0xf bank_mask:0xf
v_rcp_f32 v33, v31
s_nop 0
v_fma_f32 v34, -v31, v33, 1.0
v_fma_f32 v33, v34, v33, v33
v_mov_b32 v32, v30
v_mov_b32 v3, 0
s_mov_b64 exec, 1
ds_write_b64 v3, v[32:33] offset:19744
s_mov_b64 exec, -1
s_waitcnt lgkmcnt(0)
v_mov_b32 v3, 11032
v_mov_b32 v127, 1
s_mov_b64 exec, 1
ds_add_u32 v3, v127
s_mov_b64 exec, -1
s_setprio 0
s_waitcnt vmcnt(0)
s_cmp_eq_u32 s80, 0
s_cbranch_scc1 L_tail
v_and_b32 v85, 31, v1
v_lshlrev_b32 v85, 14, v85
s_lshl_b32 s40, s33, 11
s_add_u32 s40, s40, 1008
s_mov_b32 s50, 400000
L_proof:
buffer_load_dwordx4 v[128:131], v85, s[72:75], s40 offen sc1
buffer_load_dword v132, v85, s[72:75], s40 offen offset:268 sc1
s_waitcnt vmcnt(0)
v_add3_u32 v28, v128, v129, v130
v_add3_u32 v28, v28, v131, v132
v_cmp_ne_u32 vcc, s83, v28
s_nop 0
s_cmp_eq_u64 vcc, 0
s_cbranch_scc1 L_proof_ok
s_mov_b64 exec, vcc
s_sleep 32
s_sub_u32 s50, s50, 1
s_cmp_lg_u32 s50, 0
s_cbranch_scc1 L_proof
L_proof_ok:
s_mov_b64 exec, -1
buffer_load_dwordx2 v[100:101], v90, s[56:59], 0 offen
s_waitcnt vmcnt(0)
v_lshlrev_b32 v96, 16, v100
v_and_b32 v97, 0xffff0000, v100
v_lshlrev_b32 v98, 16, v101
v_and_b32 v99, 0xffff0000, v101
L_tail:
v_bfe_u32 v86, v1, 2, 2
v_lshrrev_b32 v104, 5, v1
v_lshl_add_u32 v104, v104, 2, v86
v_lshlrev_b32 v104, 11, v104
v_bfe_u32 v86, v1, 4, 1
v_and_b32 v106, 3, v1
v_lshl_add_u32 v106, v86, 2, v106
v_lshl_add_u32 v104, v106, 4, v104
s_lshl_b32 s37, s36, 7
v_add_u32 v104, s37, v104
v_lshrrev_b32 v107, 5, v1
v_mul_u32_u24 v107, 192, v107
v_lshl_add_u32 v107, v106, 2, v107
s_mul_i32 s37, s36, 384
v_add_u32 v107, s37, v107
v_mul_u32_u24 v108, 48, v66
v_add_u32 v108, s37, v108
s_lshl_b32 s40, s32, 14
s_add_u32 s40, s40, 2097152
v_mov_b32 v16, 0
v_mov_b32 v17, 0
v_mov_b32 v18, 0
v_mov_b32 v19, 0
s_waitcnt vmcnt(0) lgkmcnt(0)
s_barrier
s_mov_b32 s50, 400000
buffer_load_dwordx4 v[128:131], v104, s[72:75], s40 offen offset:0 sc1
buffer_load_dwordx4 v[132:135], v104, s[72:75], s40 offen offset:512 sc1
buffer_load_dwordx4 v[136:139], v104, s[72:75], s40 offen offset:1024 sc1
buffer_load_dwordx4 v[140:143], v104, s[72:75], s40 offen offset:1536 sc1
buffer_load_dwordx4 v[128:131], v104, s[72:75], s40 offen offset:0 sc1
buffer_load_dwordx4 v[132:135], v104, s[72:75], s40 offen offset:512 sc1
buffer_load_dwordx4 v[136:139], v104, s[72:75], s40 offen offset:1024 sc1
buffer_load_dwordx4 v[140:143], v104, s[72:75], s40 offen offset:1536 sc1
L_x2:
s_waitcnt vmcnt(4)
v_max3_u32 v36, v128, v129, v130
v_max3_u32 v36, v36, v131, v132
v_max3_u32 v36, v36, v133, v134
v_max3_u32 v36, v36, v135, v136
v_max3_u32 v36, v36, v137, v138
v_max3_u32 v36, v36, v139, v140
v_max3_u32 v36, v36, v141, v142
v_max_u32 v36, v36, v143
v_cmp_eq_u32 vcc, -1, v36
s_nop 0
s_cmp_eq_u64 vcc, 0
s_cbranch_scc1 L_x2_ok
s_mov_b64 exec, vcc
buffer_load_dwordx4 v[128:131], v104, s[72:75], s40 offen offset:0 sc1
buffer_load_dwordx4 v[132:135], v104, s[72:75], s40 offen offset:512 sc1
buffer_load_dwordx4 v[136:139], v104, s[72:75], s40 offen offset:1024 sc1
buffer_load_dwordx4 v[140:143], v104, s[72:75], s40 offen offset:1536 sc1
s_sub_u32 s50, s50, 1
s_cmp_lg_u32 s50, 0
s_cbranch_scc1 L_x2
L_x2_ok:
s_mov_b64 exec, -1
v_add_f32 v28, v128, v132
v_add_f32 v32, v136, v140
v_add_f32 v29, v129, v133
v_add_f32 v33, v137, v141
v_add_f32 v30, v130, v134
v_add_f32 v34, v138, v142
v_add_f32 v31, v131, v135
v_add_f32 v35, v139, v143
v_add_f32 v28, v28, v32
v_add_f32 v29, v29, v33
v_add_f32 v30, v30, v34
v_add_f32 v31, v31, v35
v_add_f32_dpp v28, v28, v28 row_ror:4 row_mask:0xf bank_mask:0xf
v_add_f32_dpp v29, v29, v29 row_ror:4 row_mask:0xf bank_mask:0xf
v_add_f32_dpp v30, v30, v30 row_ror:4 row_mask:0xf bank_mask:0xf
v_add_f32_dpp v31, v31, v31 row_ror:4 row_mask:0xf bank_mask:0xf
v_add_f32_dpp v28, v28, v28 row_ror:8 row_mask:0xf bank_mask:0xf
v_add_f32_dpp v29, v29, v29 row_ror:8 row_mask:0xf bank_mask:0xf
v_add_f32_dpp v30, v30, v30 row_ror:8 row_mask:0xf bank_mask:0xf
v_add_f32_dpp v31, v31, v31 row_ror:8 row_mask:0xf bank_mask:0xf
v_cvt_pk_bf16_f32 v28, v28, v28
v_cvt_pk_bf16_f32 v29, v29, v29
v_cvt_pk_bf16_f32 v30, v30, v30
v_cvt_pk_bf16_f32 v31, v31, v31
ds_write_b32 v107, v28 offset:9472
ds_write_b32 v107, v29 offset:9520
ds_write_b32 v107, v30 offset:9568
ds_write_b32 v107, v31 offset:9616
ds_read_b128 v[44:47], v108 offset:9472
ds_read_b128 v[48:51], v108 offset:9488
s_waitcnt lgkmcnt(0)
v_and_b32 v8, v44, v4
v_and_b32 v9, v44, v5
v_and_b32 v10, v44, v6
v_and_b32 v11, v44, v7
v_and_b32 v12, v45, v4
v_and_b32 v13, v45, v5
v_and_b32 v14, v45, v6
v_and_b32 v15, v45, v7
v_mfma_f32_16x16x32_bf16 v[16:19], v[8:11], v[224:227], v[16:19]
v_and_b32 v8, v46, v4
v_and_b32 v9, v46, v5
v_and_b32 v10, v46, v6
v_and_b32 v11, v46, v7
v_mfma_f32_16x16x32_bf16 v[16:19], v[12:15], v[228:231], v[16:19]
v_and_b32 v12, v47, v4
v_and_b32 v13, v47, v5
v_and_b32 v14, v47, v6
v_and_b32 v15, v47, v7
v_mfma_f32_16x16x32_bf16 v[16:19], v[8:11], v[232:235], v[16:19]
v_and_b32 v8, v48, v4
v_and_b32 v9, v48, v5
v_and_b32 v10, v48, v6
v_and_b32 v11, v48, v7
v_mfma_f32_16x16x32_bf16 v[16:19], v[12:15], v[236:239], v[16:19]
v_and_b32 v12, v49, v4
v_and_b32 v13, v49, v5
v_and_b32 v14, v49, v6
v_and_b32 v15, v49, v7
v_mfma_f32_16x16x32_bf16 v[16:19], v[8:11], v[240:243], v[16:19]
v_and_b32 v8, v50, v4
v_and_b32 v9, v50, v5
v_and_b32 v10, v50, v6
v_and_b32 v11, v50, v7
v_mfma_f32_16x16x32_bf16 v[16:19], v[12:15], v[244:247], v[16:19]
v_and_b32 v12, v51, v4
v_and_b32 v13, v51, v5
v_and_b32 v14, v51, v6
v_and_b32 v15, v51, v7
v_mfma_f32_16x16x32_bf16 v[16:19], v[8:11], v[248:251], v[16:19]
s_nop 0
v_mfma_f32_16x16x32_bf16 v[16:19], v[12:15], v[252:255], v[16:19]
s_cmp_eq_u32 s36, 0
s_cbranch_scc1 L_x3_h0
s_nop 5
ds_write_b128 v84, v[16:19] offset:19968
s_endpgm
L_x3_h0:
s_mov_b32 s51, 1600000
L_r3:
ds_read_b128 v[32:35], v2 offset:20992
ds_read_b128 v[36:39], v2 offset:22016
ds_read_b128 v[40:43], v2 offset:23040
s_waitcnt lgkmcnt(0)
v_max3_u32 v28, v32, v33, v34
v_max3_u32 v28, v28, v35, v36
v_max3_u32 v28, v28, v37, v38
v_max3_u32 v28, v28, v39, v40
v_max3_u32 v28, v28, v41, v42
v_max_u32 v28, v28, v43
v_cmp_eq_u32 vcc, -1, v28
s_nop 0
s_cmp_eq_u64 vcc, 0
s_cbranch_scc1 L_r3_ok
s_sub_u32 s51, s51, 1
s_cmp_lg_u32 s51, 0
s_cbranch_scc1 L_r3
L_r3_ok:
v_add_f32 v16, v16, v32
v_add_f32 v36, v36, v40
v_add_f32 v17, v17, v33
v_add_f32 v37, v37, v41
v_add_f32 v18, v18, v34
v_add_f32 v38, v38, v42
v_add_f32 v19, v19, v35
v_add_f32 v39, v39, v43
v_add_f32 v16, v16, v36
v_add_f32 v17, v17, v37
v_add_f32 v18, v18, v38
v_add_f32 v19, v19, v39
s_add_u32 s37, s82, 3145728
buffer_store_dwordx4 v[16:19], v87, s[72:75], s37 offen sc1
s_cmp_eq_u32 s80, 0
s_cbranch_scc1 L_fin
v_and_b32 v85, 15, v1
v_lshlrev_b32 v85, 4, v85
v_mov_b32 v3, 11052
s_mov_b32 s51, 1600000
Lw_14:
ds_read_b32 v127, v3
s_waitcnt lgkmcnt(0)
v_readfirstlane_b32 s37, v127
s_nop 0
s_cmp_ge_u32 s37, 1
s_cbranch_scc1 Lw_14_ok
s_sub_u32 s51, s51, 1
s_cmp_lg_u32 s51, 0
s_cbranch_scc1 Lw_14
Lw_14_ok:
ds_read_b128 v[92:95], v85 offset:19968
s_mov_b32 s50, 400000
s_lshl_b32 s40, s33, 15
s_lshl_b32 s38, s81, 7
s_add_u32 s40, s40, s38
s_add_u32 s40, s40, 3145728
buffer_load_dwordx4 v[160:163], v88, s[72:75], s40 offen sc1
s_add_u32 s40, s40, 4096
buffer_load_dwordx4 v[164:167], v88, s[72:75], s40 offen sc1
s_add_u32 s40, s40, 4096
buffer_load_dwordx4 v[168:171], v88, s[72:75], s40 offen sc1
s_add_u32 s40, s40, 4096
buffer_load_dwordx4 v[172:175], v88, s[72:75], s40 offen sc1
s_add_u32 s40, s40, 4096
buffer_load_dwordx4 v[176:179], v88, s[72:75], s40 offen sc1
s_add_u32 s40, s40, 4096
buffer_load_dwordx4 v[180:183], v88, s[72:75], s40 offen sc1
s_add_u32 s40, s40, 4096
buffer_load_dwordx4 v[184:187], v88, s[72:75], s40 offen sc1
s_add_u32 s40, s40, 4096
buffer_load_dwordx4 v[188:191], v88, s[72:75], s40 offen sc1
s_lshl_b32 s40, s33, 15
s_lshl_b32 s38, s81, 7
s_add_u32 s40, s40, s38
s_add_u32 s40, s40, 3145728
buffer_load_dwordx4 v[160:163], v88, s[72:75], s40 offen sc1
s_add_u32 s40, s40, 4096
buffer_load_dwordx4 v[164:167], v88, s[72:75], s40 offen sc1
s_add_u32 s40, s40, 4096
buffer_load_dwordx4 v[168:171], v88, s[72:75], s40 offen sc1
s_add_u32 s40, s40, 4096
buffer_load_dwordx4 v[172:175], v88, s[72:75], s40 offen sc1
s_add_u32 s40, s40, 4096
buffer_load_dwordx4 v[176:179], v88, s[72:75], s40 offen sc1
s_add_u32 s40, s40, 4096
buffer_load_dwordx4 v[180:183], v88, s[72:75], s40 offen sc1
s_add_u32 s40, s40, 4096
buffer_load_dwordx4 v[184:187], v88, s[72:75], s40 offen sc1
s_add_u32 s40, s40, 4096
buffer_load_dwordx4 v[188:191], v88, s[72:75], s40 offen sc1
L_g3:
s_waitcnt vmcnt(8)
v_max3_u32 v32, v160, v161, v162
v_max3_u32 v32, v32, v163, v164
v_max3_u32 v32, v32, v165, v166
v_max3_u32 v32, v32, v167, v168
v_max3_u32 v32, v32, v169, v170
v_max3_u32 v32, v32, v171, v172
v_max3_u32 v32, v32, v173, v174
v_max3_u32 v32, v32, v175, v176
v_max3_u32 v32, v32, v177, v178
v_max3_u32 v32, v32, v179, v180
v_max3_u32 v32, v32, v181, v182
v_max3_u32 v32, v32, v183, v184
v_max3_u32 v32, v32, v185, v186
v_max3_u32 v32, v32, v187, v188
v_max3_u32 v32, v32, v189, v190
v_max_u32 v32, v32, v191
v_cmp_eq_u32 vcc, -1, v32
s_nop 0
s_cmp_eq_u64 vcc, 0
s_cbranch_scc1 L_g3_ok
s_mov_b64 exec, vcc
s_lshl_b32 s40, s33, 15
s_lshl_b32 s38, s81, 7
s_add_u32 s40, s40, s38
s_add_u32 s40, s40, 3145728
buffer_load_dwordx4 v[160:163], v88, s[72:75], s40 offen sc1
s_add_u32 s40, s40, 4096
buffer_load_dwordx4 v[164:167], v88, s[72:75], s40 offen sc1
s_add_u32 s40, s40, 4096
buffer_load_dwordx4 v[168:171], v88, s[72:75], s40 offen sc1
s_add_u32 s40, s40, 4096
buffer_load_dwordx4 v[172:175], v88, s[72:75], s40 offen sc1
s_add_u32 s40, s40, 4096
buffer_load_dwordx4 v[176:179], v88, s[72:75], s40 offen sc1
s_add_u32 s40, s40, 4096
buffer_load_dwordx4 v[180:183], v88, s[72:75], s40 offen sc1
s_add_u32 s40, s40, 4096
buffer_load_dwordx4 v[184:187], v88, s[72:75], s40 offen sc1
s_add_u32 s40, s40, 4096
buffer_load_dwordx4 v[188:191], v88, s[72:75], s40 offen sc1
s_sub_u32 s50, s50, 1
s_cmp_lg_u32 s50, 0
s_cbranch_scc1 L_g3
L_g3_ok:
s_mov_b64 exec, -1
v_add_f32 v28, v160, v164
v_add_f32 v32, v168, v172
v_add_f32 v36, v176, v180
v_add_f32 v40, v184, v188
v_add_f32 v29, v161, v165
v_add_f32 v33, v169, v173
v_add_f32 v37, v177, v181
v_add_f32 v41, v185, v189
v_add_f32 v30, v162, v166
v_add_f32 v34, v170, v174
v_add_f32 v38, v178, v182
v_add_f32 v42, v186, v190
v_add_f32 v31, v163, v167
v_add_f32 v35, v171, v175
v_add_f32 v39, v179, v183
v_add_f32 v43, v187, v191
v_add_f32 v28, v28, v32
v_add_f32 v36, v36, v40
v_add_f32 v29, v29, v33
v_add_f32 v37, v37, v41
v_add_f32 v30, v30, v34
v_add_f32 v38, v38, v42
v_add_f32 v31, v31, v35
v_add_f32 v39, v39, v43
v_add_f32 v28, v28, v36
v_add_f32 v29, v29, v37
v_add_f32 v30, v30, v38
v_add_f32 v31, v31, v39
v_mov_b32 v32, v28
v_mov_b32 v33, v29
v_mov_b32 v34, v30
v_mov_b32 v35, v31
v_permlane16_swap_b32 v28, v32
v_permlane16_swap_b32 v29, v33
v_permlane16_swap_b32 v30, v34
v_permlane16_swap_b32 v31, v35
v_add_f32 v28, v28, v32
v_add_f32 v29, v29, v33
v_add_f32 v30, v30, v34
v_add_f32 v31, v31, v35
v_mov_b32 v32, v28
v_mov_b32 v33, v29
v_mov_b32 v34, v30
v_mov_b32 v35, v31
v_permlane32_swap_b32 v28, v32
v_permlane32_swap_b32 v29, v33
v_permlane32_swap_b32 v30, v34
v_permlane32_swap_b32 v31, v35
v_add_f32 v28, v28, v32
v_add_f32 v29, v29, v33
v_add_f32 v30, v30, v34
v_add_f32 v31, v31, v35
v_cvt_pk_bf16_f32 v28, v28, v28
v_and_b32 v28, 0xffff0000, v28
v_cvt_pk_bf16_f32 v29, v29, v29
v_and_b32 v29, 0xffff0000, v29
v_cvt_pk_bf16_f32 v30, v30, v30
v_and_b32 v30, 0xffff0000, v30
v_cvt_pk_bf16_f32 v31, v31, v31
v_and_b32 v31, 0xffff0000, v31
s_waitcnt lgkmcnt(0)
v_mul_f32 v28, v28, v92
v_mul_f32 v29, v29, v93
v_mul_f32 v30, v30, v94
v_mul_f32 v31, v31, v95
v_cvt_pk_bf16_f32 v28, v28, v28
v_and_b32 v28, 0xffff0000, v28
v_cvt_pk_bf16_f32 v29, v29, v29
v_and_b32 v29, 0xffff0000, v29
v_cvt_pk_bf16_f32 v30, v30, v30
v_and_b32 v30, 0xffff0000, v30
v_cvt_pk_bf16_f32 v31, v31, v31
v_and_b32 v31, 0xffff0000, v31
v_add_f32 v28, v28, v96
v_add_f32 v29, v29, v97
v_add_f32 v30, v30, v98
v_add_f32 v31, v31, v99
v_cvt_pk_bf16_f32 v32, v28, v29
v_cvt_pk_bf16_f32 v33, v30, v31
s_mov_b32 s60, s26
s_mov_b32 s61, s27
s_mov_b32 s62, 4096
s_mov_b32 s63, 0x20000
s_mov_b64 exec, 0xffff
buffer_store_dwordx2 v[32:33], v90, s[60:63], 0 offen
s_cmp_lg_u32 s2, 0
s_cbranch_scc1 L_noepoch
v_mov_b32 v28, s83
v_mov_b32 v29, 5242880
s_mov_b64 exec, 1
buffer_store_dword v28, v29, s[72:75], 0 offen sc1
L_noepoch:
s_mov_b64 exec, -1
L_fin:
L_end:
s_endpgm
.section .rodata,"a"
.p2align 6
.amdhsa_kernel recurrent_scan__mha_block_cached__swiglu_ffn__decode_kernel
  .amdhsa_next_free_vgpr 256
  .amdhsa_next_free_sgpr 96
  .amdhsa_accum_offset 256
  .amdhsa_group_segment_fixed_size 0
  .amdhsa_kernarg_size 96
  .amdhsa_user_sgpr_count 2
  .amdhsa_user_sgpr_kernarg_segment_ptr 1
  .amdhsa_system_sgpr_workgroup_id_x 1
  .amdhsa_float_denorm_mode_32 3
.end_amdhsa_kernel
```
